```python
import torch

def _softmax(x, axis=-1):
    return torch.softmax(x, dim=axis)
def _gelu(x):
    return torch.nn.functional.gelu(x, approximate="tanh")
def _silu(x):
    return torch.nn.functional.silu(x)
def _sigmoid(x):
    return torch.sigmoid(x)
def _layernorm(x, axis=-1, eps=1e-5):
    m = x.mean(dim=axis, keepdim=True)
    v = x.var(dim=axis, keepdim=True, unbiased=False)
    return (x - m) / torch.sqrt(v + eps)
def _scatter_add(tgt, idx, src, axis=0):
    return tgt.clone().index_add_(axis, idx, src)
def _segment_sum(src, seg, n):
    out = torch.zeros((n,) + src.shape[1:], dtype=src.dtype)
    return out.index_add_(0, seg, src)
def _pad(x, pw):
    flat = tuple(v for pair in reversed(pw) for v in pair)
    return torch.nn.functional.pad(x, flat)

kernel_name = 'gated_mix__mha_block__mixer_channel_mlp__prompt'

def setup_inputs():

    _w = (lambda a: (lambda t: t.to(torch.bfloat16) if t.is_floating_point() else t)(torch.as_tensor(a)))
    def _A_setup():
        B, S, D, H = 1, 2048, 512, 32
        return {
            "x": _w((lambda *s: torch.randn(*s, dtype=torch.bfloat16) * 0.05)(B, S, D)),
            "wqkv": _w((lambda *s: torch.randn(*s, dtype=torch.bfloat16) * 0.8)(D, 3 * D)),
            "wo": _w((lambda *s: torch.randn(*s, dtype=torch.bfloat16) * 0.1)(D, D)),
        }
    _A_in = _A_setup()

    def _B_setup():
        B, S, D, F = 1, 2048, 512, 1792
        return {
            "x": _w((lambda *s: torch.randn(*s, dtype=torch.bfloat16) * 0.05)(B, S, D)),
            "w1": _w((lambda *s: torch.randn(*s, dtype=torch.bfloat16) * 1.6)(D, F) * (D ** -0.5)),
            "b1": _w((lambda *s: torch.randn(*s, dtype=torch.bfloat16) * 0.8)(F)),
            "w2": _w((lambda *s: torch.randn(*s, dtype=torch.bfloat16) * 0.05)(F, D) * (F ** -0.5)),
            "b2": _w((lambda *s: torch.randn(*s, dtype=torch.bfloat16) * 0.05)(D)),
        }
    _B_in = _B_setup()

    return {
        "A_x": _A_in["x"],
        "A_wqkv": _A_in["wqkv"],
        "A_wo": _A_in["wo"],
        "B_x": _B_in["x"],
        "B_w1": _B_in["w1"],
        "B_b1": _B_in["b1"],
        "B_w2": _B_in["w2"],
        "B_b2": _B_in["b2"],
        "gate_w": _w((lambda *s: torch.randn(*s, dtype=torch.bfloat16) * 0.05)(512) * 16.0),
    }

def reference(A_x, A_wqkv, A_wo, B_x, B_w1, B_b1, B_w2, B_b2, gate_w):
    def _A_ref(x, wqkv, wo):
        B, S, D = x.shape
        H = 32
        Dh = D // H
        qkv = (lambda x, *d: x.permute(*d))((x @ wqkv).reshape(B, S, 3, H, Dh), 2, 0, 3, 1, 4)
        q, k, v = qkv[0], qkv[1], qkv[2]
        scores = torch.einsum("bhqd,bhkd->bhqk", q, k) * (Dh ** -0.5)
        p = _softmax(scores, axis=-1)
        o = torch.einsum("bhqk,bhkd->bhqd", p, v)
        return (lambda x, *d: x.permute(*d))(o, 0, 2, 1, 3).reshape(B, S, D) @ wo

    def _B_ref(x, w1, b1, w2, b2):
        y = _layernorm(x, axis=-1)
        h = _gelu(torch.einsum("bsd,df->bsf", y, w1) + b1)
        return torch.einsum("bsf,fd->bsd", h, w2) + b2

    x = A_x
    g = _sigmoid((x * gate_w).sum(-1, keepdims=True))
    a = _A_ref(x, A_wqkv, A_wo)
    b = _B_ref(x, B_w1, B_b1, B_w2, B_b2)
    return g * a + (1 - g) * b
```

```asm
; @launch grid=(256,1,1) block=(768,1,1) lds=163840
.amdgcn_target "amdgcn-amd-amdhsa--gfx950"
.text
.globl gated_mix__mha_block__mixer_channel_mlp__prompt_kernel
.p2align 8
.type gated_mix__mha_block__mixer_channel_mlp__prompt_kernel,@function
gated_mix__mha_block__mixer_channel_mlp__prompt_kernel:
  s_cmp_ge_u32 s2, 256
  s_cbranch_scc1 km_exit
  s_load_dwordx16 s[64:79], s[0:1], 0
  s_load_dwordx8 s[80:87], s[0:1], 64
  v_lshrrev_b32 v1, 6, v0
  v_and_b32 v0, 63, v0
  v_readfirstlane_b32 s3, v1
  s_cmp_ge_u32 s3, 8
  s_cbranch_scc1 km_gemm
  s_cmp_ge_u32 s3, 4
  s_cbranch_scc1 km_gate
  s_and_b32 s30, s2, 7
  s_lshr_b32 s31, s2, 3
  s_and_b32 s28, s30, 3
  s_lshl_b32 s28, s28, 3
  s_and_b32 s32, s31, 7
  s_add_u32 s28, s28, s32
  s_lshr_b32 s29, s30, 2
  s_lshl_b32 s29, s29, 2
  s_lshr_b32 s32, s31, 3
  s_add_u32 s29, s29, s32
  s_mov_b32 s61, 0
  s_and_b32 s32, s3, 1
  s_lshl_b32 s32, s32, 2
  v_lshrrev_b32 v5, 4, v0
  v_or_b32 v5, s32, v5
  v_and_b32 v6, 7, v0
  v_xor_b32 v5, v5, v6
  v_lshlrev_b32 v5, 4, v5
  v_lshrrev_b32 v4, 3, v0
  v_lshl_add_u32 v2, v4, 10, v5
  v_mul_u32_u24 v3, 3072, v4
  v_bfe_u32 v5, v0, 4, 1
  v_lshlrev_b32 v5, 2, v5
  v_xor_b32 v5, v5, v6
  v_lshl_add_u32 v3, v5, 4, v3
  v_lshlrev_b32 v4, 4, v0
  s_lshl_b32 s33, s28, 16
  s_lshl_b32 s34, s3, 13
  s_add_u32 s33, s33, s34
  s_mul_i32 s34, s3, 49152
  s_add_u32 s38, s29, 1
  s_and_b32 s38, s38, 7
  s_lshl_b32 s38, s38, 7
  s_add_u32 s38, s38, s34
  s_add_u32 s38, s38, 1024
  s_add_u32 s39, s29, 2
  s_and_b32 s39, s39, 7
  s_lshl_b32 s39, s39, 7
  s_add_u32 s39, s39, s34
  s_add_u32 s39, s39, 2048
  s_lshl_b32 s35, s29, 7
  s_add_u32 s34, s34, s35
  s_lshl_b32 s35, s3, 10
  s_add_u32 s35, s35, 73728
  s_mul_i32 s36, s3, 6144
  s_waitcnt lgkmcnt(0)
  s_mov_b32 s16, s64
  s_mov_b32 s17, s65
  s_mov_b32 s18, 0x200000
  s_mov_b32 s19, 0x20000
  s_mov_b32 s20, s66
  s_mov_b32 s21, s67
  s_mov_b32 s22, 0x180000
  s_mov_b32 s23, 0x20000
  s_add_u32 s40, s61, 0
  s_and_b32 s40, s40, 7
  s_lshl_b32 s41, s40, 7
  s_add_u32 s41, s41, s33
  s_mul_i32 s40, s40, 196608
  s_add_u32 m0, s35, 0
  s_add_u32 s37, s41, 0
  buffer_load_dwordx4 v2, s[16:19], s37 offen lds
  s_add_u32 m0, s35, 4096
  s_add_u32 s37, s41, 32768
  buffer_load_dwordx4 v2, s[16:19], s37 offen lds
  s_add_u32 m0, s36, 0
  s_add_u32 s37, s34, s40
  buffer_load_dwordx4 v3, s[20:23], s37 offen lds
  s_add_u32 m0, s36, 1024
  s_add_u32 s37, s38, s40
  buffer_load_dwordx4 v3, s[20:23], s37 offen lds
  s_add_u32 m0, s36, 2048
  s_add_u32 s37, s39, s40
  buffer_load_dwordx4 v3, s[20:23], s37 offen lds
  s_add_u32 s40, s40, 24576
  s_add_u32 m0, s36, 3072
  s_add_u32 s37, s34, s40
  buffer_load_dwordx4 v3, s[20:23], s37 offen lds
  s_add_u32 m0, s36, 4096
  s_add_u32 s37, s38, s40
  buffer_load_dwordx4 v3, s[20:23], s37 offen lds
  s_add_u32 m0, s36, 5120
  s_add_u32 s37, s39, s40
  buffer_load_dwordx4 v3, s[20:23], s37 offen lds
  s_add_u32 s40, s61, 1
  s_and_b32 s40, s40, 7
  s_lshl_b32 s41, s40, 7
  s_add_u32 s41, s41, s33
  s_mul_i32 s40, s40, 196608
  s_add_u32 m0, s35, 8192
  s_add_u32 s37, s41, 0
  buffer_load_dwordx4 v2, s[16:19], s37 offen lds
  s_add_u32 m0, s35, 12288
  s_add_u32 s37, s41, 32768
  buffer_load_dwordx4 v2, s[16:19], s37 offen lds
  s_add_u32 m0, s36, 24576
  s_add_u32 s37, s34, s40
  buffer_load_dwordx4 v3, s[20:23], s37 offen lds
  s_add_u32 m0, s36, 25600
  s_add_u32 s37, s38, s40
  buffer_load_dwordx4 v3, s[20:23], s37 offen lds
  s_add_u32 m0, s36, 26624
  s_add_u32 s37, s39, s40
  buffer_load_dwordx4 v3, s[20:23], s37 offen lds
  s_add_u32 s40, s40, 24576
  s_add_u32 m0, s36, 27648
  s_add_u32 s37, s34, s40
  buffer_load_dwordx4 v3, s[20:23], s37 offen lds
  s_add_u32 m0, s36, 28672
  s_add_u32 s37, s38, s40
  buffer_load_dwordx4 v3, s[20:23], s37 offen lds
  s_add_u32 m0, s36, 29696
  s_add_u32 s37, s39, s40
  buffer_load_dwordx4 v3, s[20:23], s37 offen lds
  s_mov_b32 s12, s86
  s_mov_b32 s13, s87
  s_mov_b32 s14, 0x1800000
  s_mov_b32 s15, 0x20000
  v_lshlrev_b32 v5, 2, v0
  v_add_u32 v5, 159744, v5
  v_mov_b32 v6, 0
  ds_write_b32 v5, v6
  s_waitcnt lgkmcnt(0)
  s_waitcnt vmcnt(8)
  s_barrier
  s_add_u32 s40, s61, 2
  s_and_b32 s40, s40, 7
  s_lshl_b32 s41, s40, 7
  s_add_u32 s41, s41, s33
  s_mul_i32 s40, s40, 196608
  s_add_u32 m0, s35, 16384
  s_add_u32 s37, s41, 0
  buffer_load_dwordx4 v2, s[16:19], s37 offen lds
  s_add_u32 m0, s35, 20480
  s_add_u32 s37, s41, 32768
  buffer_load_dwordx4 v2, s[16:19], s37 offen lds
  s_add_u32 m0, s36, 49152
  s_add_u32 s37, s34, s40
  buffer_load_dwordx4 v3, s[20:23], s37 offen lds
  s_add_u32 m0, s36, 50176
  s_add_u32 s37, s38, s40
  buffer_load_dwordx4 v3, s[20:23], s37 offen lds
  s_add_u32 m0, s36, 51200
  s_add_u32 s37, s39, s40
  buffer_load_dwordx4 v3, s[20:23], s37 offen lds
  s_add_u32 s40, s40, 24576
  s_add_u32 m0, s36, 52224
  s_add_u32 s37, s34, s40
  buffer_load_dwordx4 v3, s[20:23], s37 offen lds
  s_add_u32 m0, s36, 53248
  s_add_u32 s37, s38, s40
  buffer_load_dwordx4 v3, s[20:23], s37 offen lds
  s_add_u32 m0, s36, 54272
  s_add_u32 s37, s39, s40
  buffer_load_dwordx4 v3, s[20:23], s37 offen lds
  s_waitcnt vmcnt(8)
  s_barrier
  s_add_u32 s40, s61, 3
  s_and_b32 s40, s40, 7
  s_lshl_b32 s41, s40, 7
  s_add_u32 s41, s41, s33
  s_mul_i32 s40, s40, 196608
  s_add_u32 m0, s35, 24576
  s_add_u32 s37, s41, 0
  buffer_load_dwordx4 v2, s[16:19], s37 offen lds
  s_add_u32 m0, s35, 28672
  s_add_u32 s37, s41, 32768
  buffer_load_dwordx4 v2, s[16:19], s37 offen lds
  s_add_u32 m0, s36, 0
  s_add_u32 s37, s34, s40
  buffer_load_dwordx4 v3, s[20:23], s37 offen lds
  s_add_u32 m0, s36, 1024
  s_add_u32 s37, s38, s40
  buffer_load_dwordx4 v3, s[20:23], s37 offen lds
  s_add_u32 m0, s36, 2048
  s_add_u32 s37, s39, s40
  buffer_load_dwordx4 v3, s[20:23], s37 offen lds
  s_add_u32 s40, s40, 24576
  s_add_u32 m0, s36, 3072
  s_add_u32 s37, s34, s40
  buffer_load_dwordx4 v3, s[20:23], s37 offen lds
  s_add_u32 m0, s36, 4096
  s_add_u32 s37, s38, s40
  buffer_load_dwordx4 v3, s[20:23], s37 offen lds
  s_add_u32 m0, s36, 5120
  s_add_u32 s37, s39, s40
  buffer_load_dwordx4 v3, s[20:23], s37 offen lds
  s_waitcnt vmcnt(8)
  s_barrier
  s_add_u32 s40, s61, 4
  s_and_b32 s40, s40, 7
  s_lshl_b32 s41, s40, 7
  s_add_u32 s41, s41, s33
  s_mul_i32 s40, s40, 196608
  s_add_u32 m0, s35, 32768
  s_add_u32 s37, s41, 0
  buffer_load_dwordx4 v2, s[16:19], s37 offen lds
  s_add_u32 m0, s35, 36864
  s_add_u32 s37, s41, 32768
  buffer_load_dwordx4 v2, s[16:19], s37 offen lds
  s_add_u32 m0, s36, 24576
  s_add_u32 s37, s34, s40
  buffer_load_dwordx4 v3, s[20:23], s37 offen lds
  s_add_u32 m0, s36, 25600
  s_add_u32 s37, s38, s40
  buffer_load_dwordx4 v3, s[20:23], s37 offen lds
  s_add_u32 m0, s36, 26624
  s_add_u32 s37, s39, s40
  buffer_load_dwordx4 v3, s[20:23], s37 offen lds
  s_add_u32 s40, s40, 24576
  s_add_u32 m0, s36, 27648
  s_add_u32 s37, s34, s40
  buffer_load_dwordx4 v3, s[20:23], s37 offen lds
  s_add_u32 m0, s36, 28672
  s_add_u32 s37, s38, s40
  buffer_load_dwordx4 v3, s[20:23], s37 offen lds
  s_add_u32 m0, s36, 29696
  s_add_u32 s37, s39, s40
  buffer_load_dwordx4 v3, s[20:23], s37 offen lds
  s_waitcnt vmcnt(8)
  s_barrier
  s_add_u32 s40, s61, 5
  s_and_b32 s40, s40, 7
  s_lshl_b32 s41, s40, 7
  s_add_u32 s41, s41, s33
  s_mul_i32 s40, s40, 196608
  s_add_u32 m0, s35, 40960
  s_add_u32 s37, s41, 0
  buffer_load_dwordx4 v2, s[16:19], s37 offen lds
  s_add_u32 m0, s35, 45056
  s_add_u32 s37, s41, 32768
  buffer_load_dwordx4 v2, s[16:19], s37 offen lds
  s_add_u32 m0, s36, 49152
  s_add_u32 s37, s34, s40
  buffer_load_dwordx4 v3, s[20:23], s37 offen lds
  s_add_u32 m0, s36, 50176
  s_add_u32 s37, s38, s40
  buffer_load_dwordx4 v3, s[20:23], s37 offen lds
  s_add_u32 m0, s36, 51200
  s_add_u32 s37, s39, s40
  buffer_load_dwordx4 v3, s[20:23], s37 offen lds
  s_add_u32 s40, s40, 24576
  s_add_u32 m0, s36, 52224
  s_add_u32 s37, s34, s40
  buffer_load_dwordx4 v3, s[20:23], s37 offen lds
  s_add_u32 m0, s36, 53248
  s_add_u32 s37, s38, s40
  buffer_load_dwordx4 v3, s[20:23], s37 offen lds
  s_add_u32 m0, s36, 54272
  s_add_u32 s37, s39, s40
  buffer_load_dwordx4 v3, s[20:23], s37 offen lds
  s_waitcnt vmcnt(8)
  s_barrier
  s_add_u32 s40, s61, 6
  s_and_b32 s40, s40, 7
  s_lshl_b32 s41, s40, 7
  s_add_u32 s41, s41, s33
  s_mul_i32 s40, s40, 196608
  s_add_u32 m0, s35, 49152
  s_add_u32 s37, s41, 0
  buffer_load_dwordx4 v2, s[16:19], s37 offen lds
  s_add_u32 m0, s35, 53248
  s_add_u32 s37, s41, 32768
  buffer_load_dwordx4 v2, s[16:19], s37 offen lds
  s_add_u32 m0, s36, 0
  s_add_u32 s37, s34, s40
  buffer_load_dwordx4 v3, s[20:23], s37 offen lds
  s_add_u32 m0, s36, 1024
  s_add_u32 s37, s38, s40
  buffer_load_dwordx4 v3, s[20:23], s37 offen lds
  s_add_u32 m0, s36, 2048
  s_add_u32 s37, s39, s40
  buffer_load_dwordx4 v3, s[20:23], s37 offen lds
  s_add_u32 s40, s40, 24576
  s_add_u32 m0, s36, 3072
  s_add_u32 s37, s34, s40
  buffer_load_dwordx4 v3, s[20:23], s37 offen lds
  s_add_u32 m0, s36, 4096
  s_add_u32 s37, s38, s40
  buffer_load_dwordx4 v3, s[20:23], s37 offen lds
  s_add_u32 m0, s36, 5120
  s_add_u32 s37, s39, s40
  buffer_load_dwordx4 v3, s[20:23], s37 offen lds
  s_waitcnt vmcnt(8)
  s_barrier
  s_add_u32 s40, s61, 7
  s_and_b32 s40, s40, 7
  s_lshl_b32 s41, s40, 7
  s_add_u32 s41, s41, s33
  s_mul_i32 s40, s40, 196608
  s_add_u32 m0, s35, 57344
  s_add_u32 s37, s41, 0
  buffer_load_dwordx4 v2, s[16:19], s37 offen lds
  s_add_u32 m0, s35, 61440
  s_add_u32 s37, s41, 32768
  buffer_load_dwordx4 v2, s[16:19], s37 offen lds
  s_add_u32 m0, s36, 24576
  s_add_u32 s37, s34, s40
  buffer_load_dwordx4 v3, s[20:23], s37 offen lds
  s_add_u32 m0, s36, 25600
  s_add_u32 s37, s38, s40
  buffer_load_dwordx4 v3, s[20:23], s37 offen lds
  s_add_u32 m0, s36, 26624
  s_add_u32 s37, s39, s40
  buffer_load_dwordx4 v3, s[20:23], s37 offen lds
  s_add_u32 s40, s40, 24576
  s_add_u32 m0, s36, 27648
  s_add_u32 s37, s34, s40
  buffer_load_dwordx4 v3, s[20:23], s37 offen lds
  s_add_u32 m0, s36, 28672
  s_add_u32 s37, s38, s40
  buffer_load_dwordx4 v3, s[20:23], s37 offen lds
  s_add_u32 m0, s36, 29696
  s_add_u32 s37, s39, s40
  buffer_load_dwordx4 v3, s[20:23], s37 offen lds
  v_mov_b32 v5, 0
  global_load_dword v56, v5, s[84:85] sc1
  s_waitcnt vmcnt(9)
  s_barrier
  s_and_b32 s32, s3, 1
  s_lshl_b32 s43, s32, 9
  s_lshr_b32 s42, s3, 1
  v_and_b32 v6, 31, v0
  v_lshl_add_u32 v59, v6, 4, s43
  v_add_u32 v59, 160000, v59
  s_lshl_b32 s43, s42, 2
  s_lshl_b32 s32, s32, 12
  s_lshl_b32 s42, s42, 13
  s_add_u32 s32, s32, s42
  v_mov_b32 v62, 159744
  v_mov_b32 v63, 1
  v_and_b32 v6, 31, v0
  v_lshlrev_b32 v7, 7, v6
  v_add_u32 v7, s32, v7
  v_add_u32 v7, 73728, v7
  v_bfe_u32 v6, v0, 1, 3
  v_lshrrev_b32 v58, 5, v0
  v_xor_b32 v6, v6, v58
  v_xor_b32 v58, 0, v6
  v_lshl_add_u32 v2, v58, 4, v7
  v_xor_b32 v58, 2, v6
  v_lshl_add_u32 v3, v58, 4, v7
  v_xor_b32 v58, 4, v6
  v_lshl_add_u32 v4, v58, 4, v7
  v_xor_b32 v58, 6, v6
  v_lshl_add_u32 v5, v58, 4, v7
  v_add_u32 v6, s43, v59
  ds_read_b128 v[64:67], v2 offset:0
  ds_read_b128 v[68:71], v3 offset:0
  ds_read_b128 v[72:75], v4 offset:0
  ds_read_b128 v[76:79], v5 offset:0
  s_waitcnt lgkmcnt(3)
  v_lshlrev_b32 v96, 16, v64
  v_and_b32 v97, 0xffff0000, v64
  v_lshlrev_b32 v98, 16, v65
  v_and_b32 v99, 0xffff0000, v65
  v_lshlrev_b32 v100, 16, v66
  v_and_b32 v101, 0xffff0000, v66
  v_lshlrev_b32 v102, 16, v67
  v_and_b32 v103, 0xffff0000, v67
  s_waitcnt lgkmcnt(2)
  v_lshlrev_b32 v104, 16, v68
  v_and_b32 v105, 0xffff0000, v68
  v_lshlrev_b32 v106, 16, v69
  v_and_b32 v107, 0xffff0000, v69
  v_lshlrev_b32 v108, 16, v70
  v_and_b32 v109, 0xffff0000, v70
  v_lshlrev_b32 v110, 16, v71
  v_and_b32 v111, 0xffff0000, v71
  v_pk_add_f32 v[8:9], v[96:97], v[104:105]
  v_pk_add_f32 v[10:11], v[98:99], v[106:107]
  v_pk_add_f32 v[12:13], v[100:101], v[108:109]
  v_pk_add_f32 v[14:15], v[102:103], v[110:111]
  s_waitcnt lgkmcnt(1)
  v_lshlrev_b32 v112, 16, v72
  v_and_b32 v113, 0xffff0000, v72
  v_lshlrev_b32 v114, 16, v73
  v_and_b32 v115, 0xffff0000, v73
  v_lshlrev_b32 v116, 16, v74
  v_and_b32 v117, 0xffff0000, v74
  v_lshlrev_b32 v118, 16, v75
  v_and_b32 v119, 0xffff0000, v75
  v_pk_add_f32 v[8:9], v[8:9], v[112:113]
  v_pk_add_f32 v[10:11], v[10:11], v[114:115]
  v_pk_add_f32 v[12:13], v[12:13], v[116:117]
  v_pk_add_f32 v[14:15], v[14:15], v[118:119]
  s_waitcnt lgkmcnt(0)
  v_lshlrev_b32 v120, 16, v76
  v_and_b32 v121, 0xffff0000, v76
  v_lshlrev_b32 v122, 16, v77
  v_and_b32 v123, 0xffff0000, v77
  v_lshlrev_b32 v124, 16, v78
  v_and_b32 v125, 0xffff0000, v78
  v_lshlrev_b32 v126, 16, v79
  v_and_b32 v127, 0xffff0000, v79
  v_pk_add_f32 v[8:9], v[8:9], v[120:121]
  v_pk_add_f32 v[10:11], v[10:11], v[122:123]
  v_pk_add_f32 v[12:13], v[12:13], v[124:125]
  v_pk_add_f32 v[14:15], v[14:15], v[126:127]
  s_waitcnt vmcnt(0)
  s_mov_b32 s97, 0x10000
  v_mov_b32 v57, 0
ql_init:
  v_readfirstlane_b32 s37, v56
  s_sub_u32 s97, s97, 1
  s_cbranch_scc1 ql_init_ok
  s_cmp_lg_u32 s37, 0
  s_cbranch_scc1 ql_init_ok
  global_load_dword v56, v57, s[84:85] sc1
  s_waitcnt vmcnt(0)
  s_branch ql_init
ql_init_ok:
  s_barrier
  ds_read_b128 v[80:83], v2 offset:32768
  ds_read_b128 v[84:87], v3 offset:32768
  ds_read_b128 v[88:91], v4 offset:32768
  ds_read_b128 v[92:95], v5 offset:32768
  s_waitcnt lgkmcnt(3)
  v_lshlrev_b32 v128, 16, v80
  v_and_b32 v129, 0xffff0000, v80
  v_lshlrev_b32 v130, 16, v81
  v_and_b32 v131, 0xffff0000, v81
  v_lshlrev_b32 v132, 16, v82
  v_and_b32 v133, 0xffff0000, v82
  v_lshlrev_b32 v134, 16, v83
  v_and_b32 v135, 0xffff0000, v83
  v_pk_add_f32 v[8:9], v[8:9], v[128:129]
  v_pk_add_f32 v[10:11], v[10:11], v[130:131]
  v_pk_add_f32 v[12:13], v[12:13], v[132:133]
  v_pk_add_f32 v[14:15], v[14:15], v[134:135]
  s_waitcnt lgkmcnt(2)
  v_lshlrev_b32 v136, 16, v84
  v_and_b32 v137, 0xffff0000, v84
  v_lshlrev_b32 v138, 16, v85
  v_and_b32 v139, 0xffff0000, v85
  v_lshlrev_b32 v140, 16, v86
  v_and_b32 v141, 0xffff0000, v86
  v_lshlrev_b32 v142, 16, v87
  v_and_b32 v143, 0xffff0000, v87
  v_pk_add_f32 v[8:9], v[8:9], v[136:137]
  v_pk_add_f32 v[10:11], v[10:11], v[138:139]
  v_pk_add_f32 v[12:13], v[12:13], v[140:141]
  v_pk_add_f32 v[14:15], v[14:15], v[142:143]
  s_waitcnt lgkmcnt(1)
  v_lshlrev_b32 v144, 16, v88
  v_and_b32 v145, 0xffff0000, v88
  v_lshlrev_b32 v146, 16, v89
  v_and_b32 v147, 0xffff0000, v89
  v_lshlrev_b32 v148, 16, v90
  v_and_b32 v149, 0xffff0000, v90
  v_lshlrev_b32 v150, 16, v91
  v_and_b32 v151, 0xffff0000, v91
  v_pk_add_f32 v[8:9], v[8:9], v[144:145]
  v_pk_add_f32 v[10:11], v[10:11], v[146:147]
  v_pk_add_f32 v[12:13], v[12:13], v[148:149]
  v_pk_add_f32 v[14:15], v[14:15], v[150:151]
  s_waitcnt lgkmcnt(0)
  v_lshlrev_b32 v152, 16, v92
  v_and_b32 v153, 0xffff0000, v92
  v_lshlrev_b32 v154, 16, v93
  v_and_b32 v155, 0xffff0000, v93
  v_lshlrev_b32 v156, 16, v94
  v_and_b32 v157, 0xffff0000, v94
  v_lshlrev_b32 v158, 16, v95
  v_and_b32 v159, 0xffff0000, v95
  v_pk_add_f32 v[8:9], v[8:9], v[152:153]
  v_pk_add_f32 v[10:11], v[10:11], v[154:155]
  v_pk_add_f32 v[12:13], v[12:13], v[156:157]
  v_pk_add_f32 v[14:15], v[14:15], v[158:159]
  v_pk_add_f32 v[8:9], v[8:9], v[10:11]
  v_pk_add_f32 v[12:13], v[12:13], v[14:15]
  v_pk_add_f32 v[8:9], v[8:9], v[12:13]
  v_add_f32 v8, v8, v9
  v_mov_b32 v9, v8
  s_nop 1
  v_permlane32_swap_b32 v8, v9
  s_nop 1
  v_add_f32 v8, v8, v9
  ds_write_b32 v6, v8 offset:0
  s_waitcnt lgkmcnt(0)
  s_mov_b64 exec, 1
  ds_add_u32 v62, v63 offset:44
  s_mov_b64 exec, -1
  s_mov_b32 s97, 0x40000
cx497:
  ds_read_b32 v7, v62 offset:44
  s_sub_u32 s97, s97, 1
  s_cbranch_scc1 cx497_ok
  s_waitcnt lgkmcnt(0)
  v_readfirstlane_b32 s37, v7
  s_nop 1
  s_cmp_ge_u32 s37, 8
  s_cbranch_scc0 cx497
cx497_ok:
  s_waitcnt lgkmcnt(0)
  ds_read_b128 v[8:11], v59
  s_mov_b32 s33, 0xbb000000
  s_waitcnt lgkmcnt(0)
  v_pk_add_f32 v[8:9], v[8:9], v[10:11]
  v_add_f32 v60, v8, v9
  v_mul_f32 v60, s33, v60
  v_mov_b32 v61, v60
  v_pk_add_f32 v[96:97], v[96:97], v[60:61]
  v_pk_add_f32 v[98:99], v[98:99], v[60:61]
  v_pk_add_f32 v[100:101], v[100:101], v[60:61]
  v_pk_add_f32 v[102:103], v[102:103], v[60:61]
  v_pk_mul_f32 v[8:9], v[96:97], v[96:97]
  v_pk_mul_f32 v[10:11], v[98:99], v[98:99]
  v_pk_mul_f32 v[12:13], v[100:101], v[100:101]
  v_pk_mul_f32 v[14:15], v[102:103], v[102:103]
  v_cvt_pk_bf16_f32 v64, v96, v97
  v_cvt_pk_bf16_f32 v65, v98, v99
  v_cvt_pk_bf16_f32 v66, v100, v101
  v_cvt_pk_bf16_f32 v67, v102, v103
  v_pk_add_f32 v[104:105], v[104:105], v[60:61]
  v_pk_add_f32 v[106:107], v[106:107], v[60:61]
  v_pk_add_f32 v[108:109], v[108:109], v[60:61]
  v_pk_add_f32 v[110:111], v[110:111], v[60:61]
  v_pk_fma_f32 v[8:9], v[104:105], v[104:105], v[8:9]
  v_pk_fma_f32 v[10:11], v[106:107], v[106:107], v[10:11]
  v_pk_fma_f32 v[12:13], v[108:109], v[108:109], v[12:13]
  v_pk_fma_f32 v[14:15], v[110:111], v[110:111], v[14:15]
  v_cvt_pk_bf16_f32 v68, v104, v105
  v_cvt_pk_bf16_f32 v69, v106, v107
  v_cvt_pk_bf16_f32 v70, v108, v109
  v_cvt_pk_bf16_f32 v71, v110, v111
  v_pk_add_f32 v[112:113], v[112:113], v[60:61]
  v_pk_add_f32 v[114:115], v[114:115], v[60:61]
  v_pk_add_f32 v[116:117], v[116:117], v[60:61]
  v_pk_add_f32 v[118:119], v[118:119], v[60:61]
  v_pk_fma_f32 v[8:9], v[112:113], v[112:113], v[8:9]
  v_pk_fma_f32 v[10:11], v[114:115], v[114:115], v[10:11]
  v_pk_fma_f32 v[12:13], v[116:117], v[116:117], v[12:13]
  v_pk_fma_f32 v[14:15], v[118:119], v[118:119], v[14:15]
  v_cvt_pk_bf16_f32 v72, v112, v113
  v_cvt_pk_bf16_f32 v73, v114, v115
  v_cvt_pk_bf16_f32 v74, v116, v117
  v_cvt_pk_bf16_f32 v75, v118, v119
  v_pk_add_f32 v[120:121], v[120:121], v[60:61]
  v_pk_add_f32 v[122:123], v[122:123], v[60:61]
  v_pk_add_f32 v[124:125], v[124:125], v[60:61]
  v_pk_add_f32 v[126:127], v[126:127], v[60:61]
  v_pk_fma_f32 v[8:9], v[120:121], v[120:121], v[8:9]
  v_pk_fma_f32 v[10:11], v[122:123], v[122:123], v[10:11]
  v_pk_fma_f32 v[12:13], v[124:125], v[124:125], v[12:13]
  v_pk_fma_f32 v[14:15], v[126:127], v[126:127], v[14:15]
  v_cvt_pk_bf16_f32 v76, v120, v121
  v_cvt_pk_bf16_f32 v77, v122, v123
  v_cvt_pk_bf16_f32 v78, v124, v125
  v_cvt_pk_bf16_f32 v79, v126, v127
  v_pk_add_f32 v[128:129], v[128:129], v[60:61]
  v_pk_add_f32 v[130:131], v[130:131], v[60:61]
  v_pk_add_f32 v[132:133], v[132:133], v[60:61]
  v_pk_add_f32 v[134:135], v[134:135], v[60:61]
  v_pk_fma_f32 v[8:9], v[128:129], v[128:129], v[8:9]
  v_pk_fma_f32 v[10:11], v[130:131], v[130:131], v[10:11]
  v_pk_fma_f32 v[12:13], v[132:133], v[132:133], v[12:13]
  v_pk_fma_f32 v[14:15], v[134:135], v[134:135], v[14:15]
  v_cvt_pk_bf16_f32 v80, v128, v129
  v_cvt_pk_bf16_f32 v81, v130, v131
  v_cvt_pk_bf16_f32 v82, v132, v133
  v_cvt_pk_bf16_f32 v83, v134, v135
  v_pk_add_f32 v[136:137], v[136:137], v[60:61]
  v_pk_add_f32 v[138:139], v[138:139], v[60:61]
  v_pk_add_f32 v[140:141], v[140:141], v[60:61]
  v_pk_add_f32 v[142:143], v[142:143], v[60:61]
  v_pk_fma_f32 v[8:9], v[136:137], v[136:137], v[8:9]
  v_pk_fma_f32 v[10:11], v[138:139], v[138:139], v[10:11]
  v_pk_fma_f32 v[12:13], v[140:141], v[140:141], v[12:13]
  v_pk_fma_f32 v[14:15], v[142:143], v[142:143], v[14:15]
  v_cvt_pk_bf16_f32 v84, v136, v137
  v_cvt_pk_bf16_f32 v85, v138, v139
  v_cvt_pk_bf16_f32 v86, v140, v141
  v_cvt_pk_bf16_f32 v87, v142, v143
  v_pk_add_f32 v[144:145], v[144:145], v[60:61]
  v_pk_add_f32 v[146:147], v[146:147], v[60:61]
  v_pk_add_f32 v[148:149], v[148:149], v[60:61]
  v_pk_add_f32 v[150:151], v[150:151], v[60:61]
  v_pk_fma_f32 v[8:9], v[144:145], v[144:145], v[8:9]
  v_pk_fma_f32 v[10:11], v[146:147], v[146:147], v[10:11]
  v_pk_fma_f32 v[12:13], v[148:149], v[148:149], v[12:13]
  v_pk_fma_f32 v[14:15], v[150:151], v[150:151], v[14:15]
  v_cvt_pk_bf16_f32 v88, v144, v145
  v_cvt_pk_bf16_f32 v89, v146, v147
  v_cvt_pk_bf16_f32 v90, v148, v149
  v_cvt_pk_bf16_f32 v91, v150, v151
  v_pk_add_f32 v[152:153], v[152:153], v[60:61]
  v_pk_add_f32 v[154:155], v[154:155], v[60:61]
  v_pk_add_f32 v[156:157], v[156:157], v[60:61]
  v_pk_add_f32 v[158:159], v[158:159], v[60:61]
  v_pk_fma_f32 v[8:9], v[152:153], v[152:153], v[8:9]
  v_pk_fma_f32 v[10:11], v[154:155], v[154:155], v[10:11]
  v_pk_fma_f32 v[12:13], v[156:157], v[156:157], v[12:13]
  v_pk_fma_f32 v[14:15], v[158:159], v[158:159], v[14:15]
  v_cvt_pk_bf16_f32 v92, v152, v153
  v_cvt_pk_bf16_f32 v93, v154, v155
  v_cvt_pk_bf16_f32 v94, v156, v157
  v_cvt_pk_bf16_f32 v95, v158, v159
  v_pk_add_f32 v[8:9], v[8:9], v[10:11]
  v_pk_add_f32 v[12:13], v[12:13], v[14:15]
  v_pk_add_f32 v[8:9], v[8:9], v[12:13]
  v_add_f32 v8, v8, v9
  v_mov_b32 v9, v8
  s_nop 1
  v_permlane32_swap_b32 v8, v9
  s_nop 1
  v_add_f32 v8, v8, v9
  ds_write_b32 v6, v8 offset:1024
  s_mov_b32 s97, 0x40000
cx622:
  ds_read_b32 v7, v62 offset:56
  s_sub_u32 s97, s97, 1
  s_cbranch_scc1 cx622_ok
  s_waitcnt lgkmcnt(0)
  v_readfirstlane_b32 s37, v7
  s_nop 1
  s_cmp_ge_u32 s37, 4
  s_cbranch_scc0 cx622
cx622_ok:
  s_waitcnt lgkmcnt(0)
  ds_write_b128 v2, v[64:67] offset:0
  ds_write_b128 v3, v[68:71] offset:0
  ds_write_b128 v4, v[72:75] offset:0
  ds_write_b128 v5, v[76:79] offset:0
  ds_write_b128 v2, v[80:83] offset:32768
  ds_write_b128 v3, v[84:87] offset:32768
  ds_write_b128 v4, v[88:91] offset:32768
  ds_write_b128 v5, v[92:95] offset:32768
  s_waitcnt lgkmcnt(0)
  s_barrier
  s_branch km_att
km_gate:
  s_and_b32 s30, s2, 7
  s_lshr_b32 s31, s2, 3
  s_and_b32 s28, s30, 3
  s_lshl_b32 s28, s28, 3
  s_and_b32 s32, s31, 7
  s_add_u32 s28, s28, s32
  s_lshr_b32 s29, s30, 2
  s_lshl_b32 s29, s29, 2
  s_lshr_b32 s32, s31, 3
  s_add_u32 s29, s29, s32
  s_mov_b32 s61, 0
  v_lshlrev_b32 v4, 4, v0
  s_sub_u32 s36, s3, 4
  s_waitcnt lgkmcnt(0)
  s_mov_b32 s16, s64
  s_mov_b32 s17, s65
  s_mov_b32 s18, 0x200000
  s_mov_b32 s19, 0x20000
  s_mov_b32 s12, s86
  s_mov_b32 s13, s87
  s_mov_b32 s14, 0x1800000
  s_mov_b32 s15, 0x20000
  s_barrier
  s_barrier
  s_barrier
  s_mov_b32 s24, s80
  s_mov_b32 s25, s81
  s_mov_b32 s26, 0x400
  s_mov_b32 s27, 0x20000
  s_lshl_b32 s38, s2, 3
  s_lshl_b32 s39, s36, 1
  s_add_u32 s38, s38, s39
  s_lshl_b32 s39, s38, 10
  buffer_load_dwordx4 v[8:11], v4, s[16:19], s39 offen
  buffer_load_dwordx4 v[12:15], v4, s[16:19], s39 offen offset:1024
  buffer_load_dwordx4 v[16:19], v4, s[24:27], 0 offen
  s_barrier
  s_barrier
  s_waitcnt vmcnt(0)
  v_lshlrev_b32 v24, 16, v8
  v_and_b32 v25, 0xffff0000, v8
  v_lshlrev_b32 v26, 16, v9
  v_and_b32 v27, 0xffff0000, v9
  v_lshlrev_b32 v28, 16, v10
  v_and_b32 v29, 0xffff0000, v10
  v_lshlrev_b32 v30, 16, v11
  v_and_b32 v31, 0xffff0000, v11
  v_lshlrev_b32 v32, 16, v12
  v_and_b32 v33, 0xffff0000, v12
  v_lshlrev_b32 v34, 16, v13
  v_and_b32 v35, 0xffff0000, v13
  v_lshlrev_b32 v36, 16, v14
  v_and_b32 v37, 0xffff0000, v14
  v_lshlrev_b32 v38, 16, v15
  v_and_b32 v39, 0xffff0000, v15
  v_lshlrev_b32 v40, 16, v16
  v_and_b32 v41, 0xffff0000, v16
  v_lshlrev_b32 v42, 16, v17
  v_and_b32 v43, 0xffff0000, v17
  v_lshlrev_b32 v44, 16, v18
  v_and_b32 v45, 0xffff0000, v18
  v_lshlrev_b32 v46, 16, v19
  v_and_b32 v47, 0xffff0000, v19
  v_mul_f32 v48, v24, v40
  v_mul_f32 v49, v32, v40
  v_fmac_f32 v48, v25, v41
  v_fmac_f32 v49, v33, v41
  v_fmac_f32 v48, v26, v42
  v_fmac_f32 v49, v34, v42
  v_fmac_f32 v48, v27, v43
  v_fmac_f32 v49, v35, v43
  v_fmac_f32 v48, v28, v44
  v_fmac_f32 v49, v36, v44
  v_fmac_f32 v48, v29, v45
  v_fmac_f32 v49, v37, v45
  v_fmac_f32 v48, v30, v46
  v_fmac_f32 v49, v38, v46
  v_fmac_f32 v48, v31, v47
  v_fmac_f32 v49, v39, v47
  s_nop 1
  v_add_f32_dpp v48, v48, v48 quad_perm:[1,0,3,2] row_mask:0xf bank_mask:0xf
  v_add_f32_dpp v49, v49, v49 quad_perm:[1,0,3,2] row_mask:0xf bank_mask:0xf
  s_nop 0
  v_add_f32_dpp v48, v48, v48 quad_perm:[2,3,0,1] row_mask:0xf bank_mask:0xf
  v_add_f32_dpp v49, v49, v49 quad_perm:[2,3,0,1] row_mask:0xf bank_mask:0xf
  s_nop 0
  v_add_f32_dpp v48, v48, v48 row_half_mirror row_mask:0xf bank_mask:0xf
  v_add_f32_dpp v49, v49, v49 row_half_mirror row_mask:0xf bank_mask:0xf
  s_nop 0
  v_add_f32_dpp v48, v48, v48 row_mirror row_mask:0xf bank_mask:0xf
  v_add_f32_dpp v49, v49, v49 row_mirror row_mask:0xf bank_mask:0xf
  s_nop 0
  v_mov_b32 v52, v48
  v_mov_b32 v53, v49
  s_nop 1
  v_permlane16_swap_b32 v48, v52
  v_permlane16_swap_b32 v49, v53
  s_nop 1
  v_add_f32 v48, v48, v52
  v_add_f32 v49, v49, v53
  v_mov_b32 v52, v48
  v_mov_b32 v53, v49
  s_nop 1
  v_permlane32_swap_b32 v48, v52
  v_permlane32_swap_b32 v49, v53
  s_nop 1
  v_add_f32 v48, v48, v52
  v_add_f32 v49, v49, v53
  s_mov_b32 s41, 0xbfb8aa3b
  v_cmp_eq_u32 vcc, 1, v0
  s_lshl_b32 s39, s38, 2
  s_add_u32 s39, s39, 17825792
  v_cndmask_b32 v40, v48, v49, vcc
  v_mul_f32 v40, s41, v40
  v_exp_f32 v40, v40
  v_lshlrev_b32 v41, 2, v0
  v_add_f32 v40, 1.0, v40
  v_rcp_f32 v40, v40
  s_mov_b64 exec, 3
  buffer_store_dword v40, v41, s[12:15], s39 offen sc1
  s_mov_b64 exec, -1
  s_barrier
  s_lshl_b32 s37, s28, 1
  s_and_b32 s42, s36, 1
  s_add_u32 s37, s37, s42
  s_lshl_b32 s37, s37, 15
  s_lshl_b32 s42, s29, 2
  s_and_b32 s43, s36, 2
  s_add_u32 s42, s42, s43
  s_lshl_b32 s42, s42, 10
  s_add_u32 s37, s37, s42
  s_add_u32 s37, s37, 6291456
  v_mov_b32 v48, -1
  v_mov_b32 v49, -1
  v_mov_b32 v50, -1
  v_mov_b32 v51, -1
  buffer_store_dwordx4 v[48:51], v4, s[12:15], s37 offen sc1
  buffer_store_dwordx4 v[48:51], v4, s[12:15], s37 offen offset:1024 sc1
  s_barrier
  s_and_b32 s32, s3, 1
  s_lshl_b32 s43, s32, 9
  s_lshr_b32 s42, s3, 1
  v_and_b32 v6, 31, v0
  v_lshl_add_u32 v59, v6, 4, s43
  v_add_u32 v59, 160000, v59
  s_lshl_b32 s43, s42, 2
  s_lshl_b32 s32, s32, 12
  s_lshl_b32 s42, s42, 13
  s_add_u32 s32, s32, s42
  v_mov_b32 v62, 159744
  v_mov_b32 v63, 1
  v_and_b32 v6, 31, v0
  v_lshlrev_b32 v7, 7, v6
  v_add_u32 v7, s32, v7
  v_add_u32 v7, 73728, v7
  v_bfe_u32 v6, v0, 1, 3
  v_lshrrev_b32 v58, 5, v0
  v_xor_b32 v6, v6, v58
  v_xor_b32 v58, 0, v6
  v_lshl_add_u32 v2, v58, 4, v7
  v_xor_b32 v58, 2, v6
  v_lshl_add_u32 v3, v58, 4, v7
  v_xor_b32 v58, 4, v6
  v_lshl_add_u32 v4, v58, 4, v7
  v_xor_b32 v58, 6, v6
  v_lshl_add_u32 v5, v58, 4, v7
  v_add_u32 v6, s43, v59
  ds_read_b128 v[64:67], v2 offset:0
  ds_read_b128 v[68:71], v3 offset:0
  ds_read_b128 v[72:75], v4 offset:0
  ds_read_b128 v[76:79], v5 offset:0
  s_waitcnt lgkmcnt(3)
  v_lshlrev_b32 v96, 16, v64
  v_and_b32 v97, 0xffff0000, v64
  v_lshlrev_b32 v98, 16, v65
  v_and_b32 v99, 0xffff0000, v65
  v_lshlrev_b32 v100, 16, v66
  v_and_b32 v101, 0xffff0000, v66
  v_lshlrev_b32 v102, 16, v67
  v_and_b32 v103, 0xffff0000, v67
  s_waitcnt lgkmcnt(2)
  v_lshlrev_b32 v104, 16, v68
  v_and_b32 v105, 0xffff0000, v68
  v_lshlrev_b32 v106, 16, v69
  v_and_b32 v107, 0xffff0000, v69
  v_lshlrev_b32 v108, 16, v70
  v_and_b32 v109, 0xffff0000, v70
  v_lshlrev_b32 v110, 16, v71
  v_and_b32 v111, 0xffff0000, v71
  v_pk_add_f32 v[8:9], v[96:97], v[104:105]
  v_pk_add_f32 v[10:11], v[98:99], v[106:107]
  v_pk_add_f32 v[12:13], v[100:101], v[108:109]
  v_pk_add_f32 v[14:15], v[102:103], v[110:111]
  s_waitcnt lgkmcnt(1)
  v_lshlrev_b32 v112, 16, v72
  v_and_b32 v113, 0xffff0000, v72
  v_lshlrev_b32 v114, 16, v73
  v_and_b32 v115, 0xffff0000, v73
  v_lshlrev_b32 v116, 16, v74
  v_and_b32 v117, 0xffff0000, v74
  v_lshlrev_b32 v118, 16, v75
  v_and_b32 v119, 0xffff0000, v75
  v_pk_add_f32 v[8:9], v[8:9], v[112:113]
  v_pk_add_f32 v[10:11], v[10:11], v[114:115]
  v_pk_add_f32 v[12:13], v[12:13], v[116:117]
  v_pk_add_f32 v[14:15], v[14:15], v[118:119]
  s_waitcnt lgkmcnt(0)
  v_lshlrev_b32 v120, 16, v76
  v_and_b32 v121, 0xffff0000, v76
  v_lshlrev_b32 v122, 16, v77
  v_and_b32 v123, 0xffff0000, v77
  v_lshlrev_b32 v124, 16, v78
  v_and_b32 v125, 0xffff0000, v78
  v_lshlrev_b32 v126, 16, v79
  v_and_b32 v127, 0xffff0000, v79
  v_pk_add_f32 v[8:9], v[8:9], v[120:121]
  v_pk_add_f32 v[10:11], v[10:11], v[122:123]
  v_pk_add_f32 v[12:13], v[12:13], v[124:125]
  v_pk_add_f32 v[14:15], v[14:15], v[126:127]
  s_waitcnt vmcnt(0)
  s_barrier
  ds_read_b128 v[80:83], v2 offset:32768
  ds_read_b128 v[84:87], v3 offset:32768
  ds_read_b128 v[88:91], v4 offset:32768
  ds_read_b128 v[92:95], v5 offset:32768
  s_waitcnt lgkmcnt(3)
  v_lshlrev_b32 v128, 16, v80
  v_and_b32 v129, 0xffff0000, v80
  v_lshlrev_b32 v130, 16, v81
  v_and_b32 v131, 0xffff0000, v81
  v_lshlrev_b32 v132, 16, v82
  v_and_b32 v133, 0xffff0000, v82
  v_lshlrev_b32 v134, 16, v83
  v_and_b32 v135, 0xffff0000, v83
  v_pk_add_f32 v[8:9], v[8:9], v[128:129]
  v_pk_add_f32 v[10:11], v[10:11], v[130:131]
  v_pk_add_f32 v[12:13], v[12:13], v[132:133]
  v_pk_add_f32 v[14:15], v[14:15], v[134:135]
  s_waitcnt lgkmcnt(2)
  v_lshlrev_b32 v136, 16, v84
  v_and_b32 v137, 0xffff0000, v84
  v_lshlrev_b32 v138, 16, v85
  v_and_b32 v139, 0xffff0000, v85
  v_lshlrev_b32 v140, 16, v86
  v_and_b32 v141, 0xffff0000, v86
  v_lshlrev_b32 v142, 16, v87
  v_and_b32 v143, 0xffff0000, v87
  v_pk_add_f32 v[8:9], v[8:9], v[136:137]
  v_pk_add_f32 v[10:11], v[10:11], v[138:139]
  v_pk_add_f32 v[12:13], v[12:13], v[140:141]
  v_pk_add_f32 v[14:15], v[14:15], v[142:143]
  s_waitcnt lgkmcnt(1)
  v_lshlrev_b32 v144, 16, v88
  v_and_b32 v145, 0xffff0000, v88
  v_lshlrev_b32 v146, 16, v89
  v_and_b32 v147, 0xffff0000, v89
  v_lshlrev_b32 v148, 16, v90
  v_and_b32 v149, 0xffff0000, v90
  v_lshlrev_b32 v150, 16, v91
  v_and_b32 v151, 0xffff0000, v91
  v_pk_add_f32 v[8:9], v[8:9], v[144:145]
  v_pk_add_f32 v[10:11], v[10:11], v[146:147]
  v_pk_add_f32 v[12:13], v[12:13], v[148:149]
  v_pk_add_f32 v[14:15], v[14:15], v[150:151]
  s_waitcnt lgkmcnt(0)
  v_lshlrev_b32 v152, 16, v92
  v_and_b32 v153, 0xffff0000, v92
  v_lshlrev_b32 v154, 16, v93
  v_and_b32 v155, 0xffff0000, v93
  v_lshlrev_b32 v156, 16, v94
  v_and_b32 v157, 0xffff0000, v94
  v_lshlrev_b32 v158, 16, v95
  v_and_b32 v159, 0xffff0000, v95
  v_pk_add_f32 v[8:9], v[8:9], v[152:153]
  v_pk_add_f32 v[10:11], v[10:11], v[154:155]
  v_pk_add_f32 v[12:13], v[12:13], v[156:157]
  v_pk_add_f32 v[14:15], v[14:15], v[158:159]
  v_pk_add_f32 v[8:9], v[8:9], v[10:11]
  v_pk_add_f32 v[12:13], v[12:13], v[14:15]
  v_pk_add_f32 v[8:9], v[8:9], v[12:13]
  v_add_f32 v8, v8, v9
  v_mov_b32 v9, v8
  s_nop 1
  v_permlane32_swap_b32 v8, v9
  s_nop 1
  v_add_f32 v8, v8, v9
  ds_write_b32 v6, v8 offset:0
  s_waitcnt lgkmcnt(0)
  s_mov_b64 exec, 1
  ds_add_u32 v62, v63 offset:44
  s_mov_b64 exec, -1
  s_mov_b32 s97, 0x40000
cx939:
  ds_read_b32 v7, v62 offset:44
  s_sub_u32 s97, s97, 1
  s_cbranch_scc1 cx939_ok
  s_waitcnt lgkmcnt(0)
  v_readfirstlane_b32 s37, v7
  s_nop 1
  s_cmp_ge_u32 s37, 8
  s_cbranch_scc0 cx939
cx939_ok:
  s_waitcnt lgkmcnt(0)
  ds_read_b128 v[8:11], v59
  s_mov_b32 s33, 0xbb000000
  s_waitcnt lgkmcnt(0)
  v_pk_add_f32 v[8:9], v[8:9], v[10:11]
  v_add_f32 v60, v8, v9
  v_mul_f32 v60, s33, v60
  v_mov_b32 v61, v60
  v_pk_add_f32 v[96:97], v[96:97], v[60:61]
  v_pk_add_f32 v[98:99], v[98:99], v[60:61]
  v_pk_add_f32 v[100:101], v[100:101], v[60:61]
  v_pk_add_f32 v[102:103], v[102:103], v[60:61]
  v_pk_mul_f32 v[8:9], v[96:97], v[96:97]
  v_pk_mul_f32 v[10:11], v[98:99], v[98:99]
  v_pk_mul_f32 v[12:13], v[100:101], v[100:101]
  v_pk_mul_f32 v[14:15], v[102:103], v[102:103]
  v_cvt_pk_bf16_f32 v64, v96, v97
  v_cvt_pk_bf16_f32 v65, v98, v99
  v_cvt_pk_bf16_f32 v66, v100, v101
  v_cvt_pk_bf16_f32 v67, v102, v103
  v_pk_add_f32 v[104:105], v[104:105], v[60:61]
  v_pk_add_f32 v[106:107], v[106:107], v[60:61]
  v_pk_add_f32 v[108:109], v[108:109], v[60:61]
  v_pk_add_f32 v[110:111], v[110:111], v[60:61]
  v_pk_fma_f32 v[8:9], v[104:105], v[104:105], v[8:9]
  v_pk_fma_f32 v[10:11], v[106:107], v[106:107], v[10:11]
  v_pk_fma_f32 v[12:13], v[108:109], v[108:109], v[12:13]
  v_pk_fma_f32 v[14:15], v[110:111], v[110:111], v[14:15]
  v_cvt_pk_bf16_f32 v68, v104, v105
  v_cvt_pk_bf16_f32 v69, v106, v107
  v_cvt_pk_bf16_f32 v70, v108, v109
  v_cvt_pk_bf16_f32 v71, v110, v111
  v_pk_add_f32 v[112:113], v[112:113], v[60:61]
  v_pk_add_f32 v[114:115], v[114:115], v[60:61]
  v_pk_add_f32 v[116:117], v[116:117], v[60:61]
  v_pk_add_f32 v[118:119], v[118:119], v[60:61]
  v_pk_fma_f32 v[8:9], v[112:113], v[112:113], v[8:9]
  v_pk_fma_f32 v[10:11], v[114:115], v[114:115], v[10:11]
  v_pk_fma_f32 v[12:13], v[116:117], v[116:117], v[12:13]
  v_pk_fma_f32 v[14:15], v[118:119], v[118:119], v[14:15]
  v_cvt_pk_bf16_f32 v72, v112, v113
  v_cvt_pk_bf16_f32 v73, v114, v115
  v_cvt_pk_bf16_f32 v74, v116, v117
  v_cvt_pk_bf16_f32 v75, v118, v119
  v_pk_add_f32 v[120:121], v[120:121], v[60:61]
  v_pk_add_f32 v[122:123], v[122:123], v[60:61]
  v_pk_add_f32 v[124:125], v[124:125], v[60:61]
  v_pk_add_f32 v[126:127], v[126:127], v[60:61]
  v_pk_fma_f32 v[8:9], v[120:121], v[120:121], v[8:9]
  v_pk_fma_f32 v[10:11], v[122:123], v[122:123], v[10:11]
  v_pk_fma_f32 v[12:13], v[124:125], v[124:125], v[12:13]
  v_pk_fma_f32 v[14:15], v[126:127], v[126:127], v[14:15]
  v_cvt_pk_bf16_f32 v76, v120, v121
  v_cvt_pk_bf16_f32 v77, v122, v123
  v_cvt_pk_bf16_f32 v78, v124, v125
  v_cvt_pk_bf16_f32 v79, v126, v127
  v_pk_add_f32 v[128:129], v[128:129], v[60:61]
  v_pk_add_f32 v[130:131], v[130:131], v[60:61]
  v_pk_add_f32 v[132:133], v[132:133], v[60:61]
  v_pk_add_f32 v[134:135], v[134:135], v[60:61]
  v_pk_fma_f32 v[8:9], v[128:129], v[128:129], v[8:9]
  v_pk_fma_f32 v[10:11], v[130:131], v[130:131], v[10:11]
  v_pk_fma_f32 v[12:13], v[132:133], v[132:133], v[12:13]
  v_pk_fma_f32 v[14:15], v[134:135], v[134:135], v[14:15]
  v_cvt_pk_bf16_f32 v80, v128, v129
  v_cvt_pk_bf16_f32 v81, v130, v131
  v_cvt_pk_bf16_f32 v82, v132, v133
  v_cvt_pk_bf16_f32 v83, v134, v135
  v_pk_add_f32 v[136:137], v[136:137], v[60:61]
  v_pk_add_f32 v[138:139], v[138:139], v[60:61]
  v_pk_add_f32 v[140:141], v[140:141], v[60:61]
  v_pk_add_f32 v[142:143], v[142:143], v[60:61]
  v_pk_fma_f32 v[8:9], v[136:137], v[136:137], v[8:9]
  v_pk_fma_f32 v[10:11], v[138:139], v[138:139], v[10:11]
  v_pk_fma_f32 v[12:13], v[140:141], v[140:141], v[12:13]
  v_pk_fma_f32 v[14:15], v[142:143], v[142:143], v[14:15]
  v_cvt_pk_bf16_f32 v84, v136, v137
  v_cvt_pk_bf16_f32 v85, v138, v139
  v_cvt_pk_bf16_f32 v86, v140, v141
  v_cvt_pk_bf16_f32 v87, v142, v143
  v_pk_add_f32 v[144:145], v[144:145], v[60:61]
  v_pk_add_f32 v[146:147], v[146:147], v[60:61]
  v_pk_add_f32 v[148:149], v[148:149], v[60:61]
  v_pk_add_f32 v[150:151], v[150:151], v[60:61]
  v_pk_fma_f32 v[8:9], v[144:145], v[144:145], v[8:9]
  v_pk_fma_f32 v[10:11], v[146:147], v[146:147], v[10:11]
  v_pk_fma_f32 v[12:13], v[148:149], v[148:149], v[12:13]
  v_pk_fma_f32 v[14:15], v[150:151], v[150:151], v[14:15]
  v_cvt_pk_bf16_f32 v88, v144, v145
  v_cvt_pk_bf16_f32 v89, v146, v147
  v_cvt_pk_bf16_f32 v90, v148, v149
  v_cvt_pk_bf16_f32 v91, v150, v151
  v_pk_add_f32 v[152:153], v[152:153], v[60:61]
  v_pk_add_f32 v[154:155], v[154:155], v[60:61]
  v_pk_add_f32 v[156:157], v[156:157], v[60:61]
  v_pk_add_f32 v[158:159], v[158:159], v[60:61]
  v_pk_fma_f32 v[8:9], v[152:153], v[152:153], v[8:9]
  v_pk_fma_f32 v[10:11], v[154:155], v[154:155], v[10:11]
  v_pk_fma_f32 v[12:13], v[156:157], v[156:157], v[12:13]
  v_pk_fma_f32 v[14:15], v[158:159], v[158:159], v[14:15]
  v_cvt_pk_bf16_f32 v92, v152, v153
  v_cvt_pk_bf16_f32 v93, v154, v155
  v_cvt_pk_bf16_f32 v94, v156, v157
  v_cvt_pk_bf16_f32 v95, v158, v159
  v_pk_add_f32 v[8:9], v[8:9], v[10:11]
  v_pk_add_f32 v[12:13], v[12:13], v[14:15]
  v_pk_add_f32 v[8:9], v[8:9], v[12:13]
  v_add_f32 v8, v8, v9
  v_mov_b32 v9, v8
  s_nop 1
  v_permlane32_swap_b32 v8, v9
  s_nop 1
  v_add_f32 v8, v8, v9
  ds_write_b32 v6, v8 offset:1024
  s_mov_b32 s97, 0x40000
cx1064:
  ds_read_b32 v7, v62 offset:56
  s_sub_u32 s97, s97, 1
  s_cbranch_scc1 cx1064_ok
  s_waitcnt lgkmcnt(0)
  v_readfirstlane_b32 s37, v7
  s_nop 1
  s_cmp_ge_u32 s37, 4
  s_cbranch_scc0 cx1064
cx1064_ok:
  s_waitcnt lgkmcnt(0)
  ds_write_b128 v2, v[64:67] offset:0
  ds_write_b128 v3, v[68:71] offset:0
  ds_write_b128 v4, v[72:75] offset:0
  ds_write_b128 v5, v[76:79] offset:0
  ds_write_b128 v2, v[80:83] offset:32768
  ds_write_b128 v3, v[84:87] offset:32768
  ds_write_b128 v4, v[88:91] offset:32768
  ds_write_b128 v5, v[92:95] offset:32768
  s_waitcnt lgkmcnt(0)
  s_barrier
km_att:
  v_lshlrev_b32 v1, 4, v0
  s_setprio 1
  s_and_b32 s6, s2, 7
  s_lshl_b32 s6, s6, 2
  s_bfe_u32 s7, s2, 0x20003
  s_add_u32 s6, s6, s7
  s_lshr_b32 s7, s2, 5
  s_lshl_b32 s17, s6, 17
  s_add_u32 s17, s17, 2097152
  s_add_u32 s8, s12, s17
  s_addc_u32 s9, s13, 0
  s_mov_b32 s10, 0x20000
  s_mov_b32 s11, 0x20000
  s_lshl_b32 s16, s7, 3
  s_add_u32 s16, s16, s3
  s_lshl_b32 s17, s6, 16
  s_lshl_b32 s18, s16, 10
  s_add_u32 s17, s17, s18
  s_add_u32 s17, s17, 0
  s_lshl_b32 s18, s3, 10
  s_mov_b32 s28, s18
  s_mov_b32 s29, s18
  v_and_b32 v9, 15, v0
  v_cmp_eq_u32 vcc, 0, v9
  v_mov_b32 v10, 0x3f803f80
  s_and_b32 s19, s18, 0xfff
  s_add_u32 s19, s19, 49152
  v_mov_b32 v11, 159744
  v_cndmask_b32 v80, 0, v10, vcc
  v_cndmask_b32 v81, 0, v10, vcc
  v_cndmask_b32 v82, 0, v10, vcc
  v_cndmask_b32 v83, 0, v10, vcc
  v_add_u32 v9, s19, v1
  ds_write_b128 v9, v[80:83]
  v_mov_b32 v12, 1
  v_and_b32 v9, 15, v0
  v_lshlrev_b32 v9, 4, v9
  v_lshrrev_b32 v10, 5, v0
  v_lshl_add_u32 v9, v10, 8, v9
  v_and_b32 v10, 16, v0
  v_cmp_eq_u32 vcc, 0, v10
  v_mov_b32 v20, 4096
  v_mov_b32 v2, 49152
  v_mov_b32 v10, 8192
  v_cndmask_b32 v20, 0, v20, vcc
  v_cndmask_b32 v2, v2, v10, vcc
  v_add_u32 v2, v2, v9
  v_add_u32 v3, v2, v20
  v_lshl_add_u32 v4, v20, 2, v2
  v_lshl_add_u32 v6, v20, 3, v2
  v_add_u32 v5, v4, v20
  v_add_u32 v7, v6, v20
  v_mov_b32 v8, 0xdddd
  s_mov_b32 s20, 0
  s_mov_b32 s21, 8
  v_mov_b64 v[64:65], 0
  v_mov_b64 v[66:67], 0
  v_mov_b64 v[68:69], 0
  v_mov_b64 v[70:71], 0
  v_mov_b64 v[72:73], 0
  v_mov_b64 v[74:75], 0
  v_mov_b64 v[76:77], 0
  v_mov_b64 v[78:79], 0
  v_mov_b64 v[104:105], 0
  v_mov_b64 v[106:107], 0
  v_mov_b64 v[108:109], 0
  v_mov_b64 v[110:111], 0
  v_mov_b64 v[40:41], 0
  v_mov_b64 v[42:43], 0
  s_lshr_b32 s23, s6, 2
  v_lshrrev_b32 v10, 2, v0
  v_mov_b32 v9, s23
  v_cmp_eq_u32 vcc, 2, v10
  s_sub_u32 s19, s23, 1
  s_and_b32 s19, s19, 7
  v_mov_b32 v13, s19
  v_cndmask_b32 v9, v9, v13, vcc
  v_cmp_eq_u32 vcc, 3, v10
  s_sub_u32 s19, s23, 2
  s_and_b32 s19, s19, 7
  v_mov_b32 v13, s19
  v_cndmask_b32 v9, v9, v13, vcc
  v_add_u32 v9, 8, v9
  v_cmp_eq_u32 vcc, 0, v10
  v_mov_b32 v13, s7
  v_and_b32 v10, 3, v0
  v_cndmask_b32 v9, v9, v13, vcc
  v_lshl_add_u32 v9, v9, 2, v10
  v_lshlrev_b32 v9, 8, v9
  v_add_u32 v9, 17907712, v9
  v_mov_b32 v10, 8
  s_cmp_lg_u32 s3, 0
  s_cbranch_scc1 fa_wq_l
  s_mov_b64 exec, 0xffff
  s_mov_b32 s97, 0x10000
fa_wq:
  buffer_load_dword v13, v9, s[12:15], 0 offen sc1
  s_waitcnt vmcnt(0)
  v_cmp_ge_u32 vcc, v13, v10
  s_sub_u32 s97, s97, 1
  s_cbranch_scc1 fa_wq_ok
  s_nop 1
  s_cmp_eq_u64 vcc, 0xffff
  s_cbranch_scc1 fa_wq_ok
  s_branch fa_wq
fa_wq_ok:
  s_mov_b64 exec, -1
  s_mov_b64 exec, 1
  ds_add_u32 v11, v12 offset:20
  s_mov_b64 exec, -1
  s_branch fa_wq_done
fa_wq_l:
  s_mov_b32 s97, 0x40000
fa_wq_lw:
  ds_read_b32 v13, v11 offset:20
  s_sub_u32 s97, s97, 1
  s_cbranch_scc1 fa_wq_lw_ok
  s_waitcnt lgkmcnt(0)
  v_readfirstlane_b32 s22, v13
  s_nop 1
  s_cmp_ge_u32 s22, 1
  s_cbranch_scc0 fa_wq_lw
fa_wq_lw_ok:
  s_waitcnt lgkmcnt(0)
fa_wq_done:
  s_add_u32 m0, s28, 0
  s_add_u32 s19, s29, 0
  buffer_load_dwordx4 v1, s[8:11], s19 offen sc1 lds
  s_add_u32 m0, s28, 8192
  s_add_u32 s19, s29, 65536
  buffer_load_dwordx4 v1, s[8:11], s19 offen sc1 lds
  s_add_u32 s28, s28, 16384
  s_add_u32 s29, s29, 8192
  buffer_load_dwordx4 v[16:19], v1, s[12:15], s17 offen sc1
  v_and_b32 v9, 31, v0
  v_lshlrev_b32 v9, 2, v9
  s_lshl_b32 s19, s16, 7
  s_add_u32 s19, s19, 17825792
  buffer_load_dword v14, v9, s[12:15], s19 offen sc1
  s_add_u32 m0, s28, 0
  s_add_u32 s19, s29, 0
  buffer_load_dwordx4 v1, s[8:11], s19 offen sc1 lds
  s_add_u32 m0, s28, 8192
  s_add_u32 s19, s29, 65536
  buffer_load_dwordx4 v1, s[8:11], s19 offen sc1 lds
  s_add_u32 s28, s28, 16384
  s_add_u32 s29, s29, 8192
  s_waitcnt vmcnt(2) lgkmcnt(0)
  s_mov_b64 exec, 1
  ds_add_u32 v11, v12 offset:0
  s_mov_b64 exec, -1
  s_mov_b32 s97, 0x40000
fa_w0:
  ds_read_b32 v9, v11 offset:0
  s_sub_u32 s97, s97, 1
  s_cbranch_scc1 fa_w0_ok
  s_waitcnt lgkmcnt(0)
  v_readfirstlane_b32 s22, v9
  s_nop 1
  s_cmp_ge_u32 s22, 8
  s_cbranch_scc0 fa_w0
fa_w0_ok:
  s_waitcnt lgkmcnt(0)
  ds_read_b128 v[24:27], v1
  ds_read_b128 v[28:31], v1 offset:1024
  ds_read_b128 v[32:35], v2
  s_waitcnt lgkmcnt(2)
  v_mfma_f32_32x32x16_bf16 v[80:95], v[24:27], v[16:19], 0
  s_nop 7
  s_nop 3
  v_max3_f32 v9, v80, v81, v82
  v_max3_f32 v9, v9, v83, v84
  v_max3_f32 v9, v9, v85, v86
  v_max3_f32 v9, v9, v87, v88
  v_max3_f32 v9, v9, v89, v90
  v_max3_f32 v9, v9, v91, v92
  v_max3_f32 v9, v9, v93, v94
  v_max_f32 v9, v9, v95
  v_mov_b32 v10, v9
  s_nop 1
  v_permlane32_swap_b32 v9, v10
  s_nop 1
  v_max_f32 v9, v9, v10
  v_sub_f32 v48, 0, v9
  v_sub_f32 v49, 0, v9
  v_mov_b64 v[50:51], v[48:49]
  v_mov_b64 v[52:53], v[48:49]
  v_mov_b64 v[54:55], v[48:49]
  v_mov_b64 v[56:57], v[48:49]
  v_mov_b64 v[58:59], v[48:49]
  v_mov_b64 v[60:61], v[48:49]
  v_mov_b64 v[62:63], v[48:49]
  s_nop 1
  v_mfma_f32_32x32x16_bf16 v[80:95], v[24:27], v[16:19], v[48:63]
  s_nop 7
  s_nop 3
  s_lshr_b32 s23, s3, 2
.p2align 6
fa_loop:
  v_exp_f32 v80, v80
  s_waitcnt lgkmcnt(0)
  v_smfmac_f32_32x32x32_bf16 v[64:79], v[40:43], v[104:111], v8
  ds_read_b128 v[44:47], v2 offset:512
  v_exp_f32 v81, v81
  v_exp_f32 v82, v82
  v_exp_f32 v83, v83
  v_exp_f32 v84, v84
  v_exp_f32 v85, v85
  v_mfma_f32_32x32x16_bf16 v[96:111], v[28:31], v[16:19], v[48:63]
  ds_read_b128 v[24:27], v1 offset:2048
  v_exp_f32 v86, v86
  v_exp_f32 v87, v87
  v_exp_f32 v88, v88
  v_exp_f32 v89, v89
  v_exp_f32 v90, v90
  v_smfmac_f32_32x32x32_bf16 v[64:79], v[32:35], v[80:87], v8
  ds_read_b128 v[36:39], v2 offset:1024
  s_cmp_eq_u32 s23, 0
  s_cbranch_scc1 fa_np00
  s_setprio 2
fa_np00:
  v_exp_f32 v91, v91
  v_exp_f32 v92, v92
  v_exp_f32 v93, v93
  v_exp_f32 v94, v94
  v_exp_f32 v95, v95
  v_exp_f32 v96, v96
  s_waitcnt lgkmcnt(0)
  v_smfmac_f32_32x32x32_bf16 v[64:79], v[44:47], v[88:95], v8
  ds_read_b128 v[40:43], v2 offset:1536
  v_exp_f32 v97, v97
  v_exp_f32 v98, v98
  v_exp_f32 v99, v99
  v_exp_f32 v100, v100
  v_exp_f32 v101, v101
  v_mfma_f32_32x32x16_bf16 v[80:95], v[24:27], v[16:19], v[48:63]
  ds_read_b128 v[28:31], v1 offset:3072
  v_exp_f32 v102, v102
  v_exp_f32 v103, v103
  v_exp_f32 v104, v104
  v_exp_f32 v105, v105
  v_exp_f32 v106, v106
  v_smfmac_f32_32x32x32_bf16 v[64:79], v[36:39], v[96:103], v8
  ds_read_b128 v[32:35], v2 offset:2048
  v_exp_f32 v107, v107
  v_exp_f32 v108, v108
  v_exp_f32 v109, v109
  v_exp_f32 v110, v110
  v_exp_f32 v111, v111
  v_exp_f32 v80, v80
  s_waitcnt lgkmcnt(0)
  v_smfmac_f32_32x32x32_bf16 v[64:79], v[40:43], v[104:111], v8
  ds_read_b128 v[44:47], v2 offset:2560
  v_exp_f32 v81, v81
  v_exp_f32 v82, v82
  v_exp_f32 v83, v83
  v_exp_f32 v84, v84
  v_exp_f32 v85, v85
  v_mfma_f32_32x32x16_bf16 v[96:111], v[28:31], v[16:19], v[48:63]
  ds_read_b128 v[24:27], v1 offset:4096
  v_exp_f32 v86, v86
  v_exp_f32 v87, v87
  v_exp_f32 v88, v88
  v_exp_f32 v89, v89
  v_exp_f32 v90, v90
  v_smfmac_f32_32x32x32_bf16 v[64:79], v[32:35], v[80:87], v8
  ds_read_b128 v[36:39], v2 offset:3072
  v_exp_f32 v91, v91
  v_exp_f32 v92, v92
  v_exp_f32 v93, v93
  v_exp_f32 v94, v94
  v_exp_f32 v95, v95
  v_exp_f32 v96, v96
  s_waitcnt lgkmcnt(0)
  v_smfmac_f32_32x32x32_bf16 v[64:79], v[44:47], v[88:95], v8
  ds_read_b128 v[40:43], v2 offset:3584
  v_exp_f32 v97, v97
  v_exp_f32 v98, v98
  v_exp_f32 v99, v99
  v_exp_f32 v100, v100
  v_exp_f32 v101, v101
  v_mfma_f32_32x32x16_bf16 v[80:95], v[24:27], v[16:19], v[48:63]
  ds_read_b128 v[28:31], v1 offset:5120
  s_waitcnt vmcnt(0)
  s_mov_b64 exec, 1
  ds_add_u32 v11, v12 offset:36
  s_mov_b64 exec, -1
  v_exp_f32 v102, v102
  v_exp_f32 v103, v103
  v_exp_f32 v104, v104
  v_exp_f32 v105, v105
  v_exp_f32 v106, v106
  v_smfmac_f32_32x32x32_bf16 v[64:79], v[36:39], v[96:103], v8
  ds_read_b128 v[32:35], v3 offset:0
  s_setprio 1
  v_exp_f32 v107, v107
  v_exp_f32 v108, v108
  v_exp_f32 v109, v109
  v_exp_f32 v110, v110
  v_exp_f32 v111, v111
  v_exp_f32 v80, v80
  s_waitcnt lgkmcnt(0)
  v_smfmac_f32_32x32x32_bf16 v[64:79], v[40:43], v[104:111], v8
  ds_read_b128 v[44:47], v3 offset:512
  v_exp_f32 v81, v81
  v_exp_f32 v82, v82
  v_exp_f32 v83, v83
  v_exp_f32 v84, v84
  v_exp_f32 v85, v85
  v_mfma_f32_32x32x16_bf16 v[96:111], v[28:31], v[16:19], v[48:63]
  ds_read_b128 v[24:27], v1 offset:6144
  ds_read_b32 v13, v11 offset:36
  v_exp_f32 v86, v86
  v_exp_f32 v87, v87
  v_exp_f32 v88, v88
  v_exp_f32 v89, v89
  v_exp_f32 v90, v90
  v_smfmac_f32_32x32x32_bf16 v[64:79], v[32:35], v[80:87], v8
  ds_read_b128 v[36:39], v3 offset:1024
  s_cmp_eq_u32 s23, 0
  s_cbranch_scc1 fa_np04
  s_setprio 2
fa_np04:
  v_exp_f32 v91, v91
  v_exp_f32 v92, v92
  v_exp_f32 v93, v93
  v_exp_f32 v94, v94
  v_exp_f32 v95, v95
  v_exp_f32 v96, v96
  s_waitcnt lgkmcnt(0)
  v_readfirstlane_b32 s22, v13
  v_smfmac_f32_32x32x32_bf16 v[64:79], v[44:47], v[88:95], v8
  ds_read_b128 v[40:43], v3 offset:1536
  s_cmp_lt_u32 s22, s21
  s_cbranch_scc1 fa_poll0
fa_polled0:
  v_exp_f32 v97, v97
  v_exp_f32 v98, v98
  v_exp_f32 v99, v99
  v_exp_f32 v100, v100
  v_exp_f32 v101, v101
  v_mfma_f32_32x32x16_bf16 v[80:95], v[24:27], v[16:19], v[48:63]
  ds_read_b128 v[28:31], v1 offset:7168
  v_exp_f32 v102, v102
  v_exp_f32 v103, v103
  v_exp_f32 v104, v104
  v_exp_f32 v105, v105
  v_exp_f32 v106, v106
  v_smfmac_f32_32x32x32_bf16 v[64:79], v[36:39], v[96:103], v8
  ds_read_b128 v[32:35], v3 offset:2048
  v_exp_f32 v107, v107
  v_exp_f32 v108, v108
  v_exp_f32 v109, v109
  v_exp_f32 v110, v110
  v_exp_f32 v111, v111
  v_exp_f32 v80, v80
  s_waitcnt lgkmcnt(0)
  v_smfmac_f32_32x32x32_bf16 v[64:79], v[40:43], v[104:111], v8
  ds_read_b128 v[44:47], v3 offset:2560
  v_exp_f32 v81, v81
  v_exp_f32 v82, v82
  v_exp_f32 v83, v83
  v_exp_f32 v84, v84
  v_exp_f32 v85, v85
  v_mfma_f32_32x32x16_bf16 v[96:111], v[28:31], v[16:19], v[48:63]
  ds_read_b128 v[24:27], v1 offset:16384
  s_add_u32 m0, s18, 32768
  s_add_u32 s19, s29, 0
  buffer_load_dwordx4 v1, s[8:11], s19 offen sc1 lds
  v_exp_f32 v86, v86
  v_exp_f32 v87, v87
  v_exp_f32 v88, v88
  v_exp_f32 v89, v89
  v_exp_f32 v90, v90
  v_smfmac_f32_32x32x32_bf16 v[64:79], v[32:35], v[80:87], v8
  ds_read_b128 v[36:39], v3 offset:3072
  v_exp_f32 v91, v91
  v_exp_f32 v92, v92
  v_exp_f32 v93, v93
  v_exp_f32 v94, v94
  v_exp_f32 v95, v95
  v_exp_f32 v96, v96
  s_waitcnt lgkmcnt(0)
  v_smfmac_f32_32x32x32_bf16 v[64:79], v[44:47], v[88:95], v8
  ds_read_b128 v[40:43], v3 offset:3584
  v_exp_f32 v97, v97
  v_exp_f32 v98, v98
  v_exp_f32 v99, v99
  v_exp_f32 v100, v100
  v_exp_f32 v101, v101
  v_mfma_f32_32x32x16_bf16 v[80:95], v[24:27], v[16:19], v[48:63]
  ds_read_b128 v[28:31], v1 offset:17408
  s_add_u32 m0, s18, 40960
  s_add_u32 s19, s29, 65536
  buffer_load_dwordx4 v1, s[8:11], s19 offen sc1 lds
  v_exp_f32 v102, v102
  v_exp_f32 v103, v103
  v_exp_f32 v104, v104
  v_exp_f32 v105, v105
  v_exp_f32 v106, v106
  v_smfmac_f32_32x32x32_bf16 v[64:79], v[36:39], v[96:103], v8
  ds_read_b128 v[32:35], v4 offset:0
  s_setprio 1
  s_add_u32 s29, s29, 8192
  s_cmp_lt_u32 s20, 5
  s_cselect_b32 s29, s29, 0x100000
  s_add_u32 s21, s21, 8
  s_add_u32 s20, s20, 1
  v_exp_f32 v107, v107
  v_exp_f32 v108, v108
  v_exp_f32 v109, v109
  v_exp_f32 v110, v110
  v_exp_f32 v111, v111
  v_exp_f32 v80, v80
  s_waitcnt lgkmcnt(0)
  v_smfmac_f32_32x32x32_bf16 v[64:79], v[40:43], v[104:111], v8
  ds_read_b128 v[44:47], v4 offset:512
  v_exp_f32 v81, v81
  v_exp_f32 v82, v82
  v_exp_f32 v83, v83
  v_exp_f32 v84, v84
  v_exp_f32 v85, v85
  v_mfma_f32_32x32x16_bf16 v[96:111], v[28:31], v[16:19], v[48:63]
  ds_read_b128 v[24:27], v1 offset:18432
  v_exp_f32 v86, v86
  v_exp_f32 v87, v87
  v_exp_f32 v88, v88
  v_exp_f32 v89, v89
  v_exp_f32 v90, v90
  v_smfmac_f32_32x32x32_bf16 v[64:79], v[32:35], v[80:87], v8
  ds_read_b128 v[36:39], v4 offset:1024
  s_cmp_eq_u32 s23, 0
  s_cbranch_scc1 fa_np10
  s_setprio 2
fa_np10:
  v_exp_f32 v91, v91
  v_exp_f32 v92, v92
  v_exp_f32 v93, v93
  v_exp_f32 v94, v94
  v_exp_f32 v95, v95
  v_exp_f32 v96, v96
  s_waitcnt lgkmcnt(0)
  v_smfmac_f32_32x32x32_bf16 v[64:79], v[44:47], v[88:95], v8
  ds_read_b128 v[40:43], v4 offset:1536
  v_exp_f32 v97, v97
  v_exp_f32 v98, v98
  v_exp_f32 v99, v99
  v_exp_f32 v100, v100
  v_exp_f32 v101, v101
  v_mfma_f32_32x32x16_bf16 v[80:95], v[24:27], v[16:19], v[48:63]
  ds_read_b128 v[28:31], v1 offset:19456
  v_exp_f32 v102, v102
  v_exp_f32 v103, v103
  v_exp_f32 v104, v104
  v_exp_f32 v105, v105
  v_exp_f32 v106, v106
  v_smfmac_f32_32x32x32_bf16 v[64:79], v[36:39], v[96:103], v8
  ds_read_b128 v[32:35], v4 offset:2048
  v_exp_f32 v107, v107
  v_exp_f32 v108, v108
  v_exp_f32 v109, v109
  v_exp_f32 v110, v110
  v_exp_f32 v111, v111
  v_exp_f32 v80, v80
  s_waitcnt lgkmcnt(0)
  v_smfmac_f32_32x32x32_bf16 v[64:79], v[40:43], v[104:111], v8
  ds_read_b128 v[44:47], v4 offset:2560
  v_exp_f32 v81, v81
  v_exp_f32 v82, v82
  v_exp_f32 v83, v83
  v_exp_f32 v84, v84
  v_exp_f32 v85, v85
  v_mfma_f32_32x32x16_bf16 v[96:111], v[28:31], v[16:19], v[48:63]
  ds_read_b128 v[24:27], v1 offset:20480
  v_exp_f32 v86, v86
  v_exp_f32 v87, v87
  v_exp_f32 v88, v88
  v_exp_f32 v89, v89
  v_exp_f32 v90, v90
  v_smfmac_f32_32x32x32_bf16 v[64:79], v[32:35], v[80:87], v8
  ds_read_b128 v[36:39], v4 offset:3072
  v_exp_f32 v91, v91
  v_exp_f32 v92, v92
  v_exp_f32 v93, v93
  v_exp_f32 v94, v94
  v_exp_f32 v95, v95
  v_exp_f32 v96, v96
  s_waitcnt lgkmcnt(0)
  v_smfmac_f32_32x32x32_bf16 v[64:79], v[44:47], v[88:95], v8
  ds_read_b128 v[40:43], v4 offset:3584
  v_exp_f32 v97, v97
  v_exp_f32 v98, v98
  v_exp_f32 v99, v99
  v_exp_f32 v100, v100
  v_exp_f32 v101, v101
  v_mfma_f32_32x32x16_bf16 v[80:95], v[24:27], v[16:19], v[48:63]
  ds_read_b128 v[28:31], v1 offset:21504
  s_waitcnt vmcnt(0)
  s_mov_b64 exec, 1
  ds_add_u32 v11, v12 offset:36
  s_mov_b64 exec, -1
  v_exp_f32 v102, v102
  v_exp_f32 v103, v103
  v_exp_f32 v104, v104
  v_exp_f32 v105, v105
  v_exp_f32 v106, v106
  v_smfmac_f32_32x32x32_bf16 v[64:79], v[36:39], v[96:103], v8
  ds_read_b128 v[32:35], v5 offset:0
  s_setprio 1
  v_exp_f32 v107, v107
  v_exp_f32 v108, v108
  v_exp_f32 v109, v109
  v_exp_f32 v110, v110
  v_exp_f32 v111, v111
  v_exp_f32 v80, v80
  s_waitcnt lgkmcnt(0)
  v_smfmac_f32_32x32x32_bf16 v[64:79], v[40:43], v[104:111], v8
  ds_read_b128 v[44:47], v5 offset:512
  v_exp_f32 v81, v81
  v_exp_f32 v82, v82
  v_exp_f32 v83, v83
  v_exp_f32 v84, v84
  v_exp_f32 v85, v85
  v_mfma_f32_32x32x16_bf16 v[96:111], v[28:31], v[16:19], v[48:63]
  ds_read_b128 v[24:27], v1 offset:22528
  ds_read_b32 v13, v11 offset:36
  v_exp_f32 v86, v86
  v_exp_f32 v87, v87
  v_exp_f32 v88, v88
  v_exp_f32 v89, v89
  v_exp_f32 v90, v90
  v_smfmac_f32_32x32x32_bf16 v[64:79], v[32:35], v[80:87], v8
  ds_read_b128 v[36:39], v5 offset:1024
  s_cmp_eq_u32 s23, 0
  s_cbranch_scc1 fa_np14
  s_setprio 2
fa_np14:
  v_exp_f32 v91, v91
  v_exp_f32 v92, v92
  v_exp_f32 v93, v93
  v_exp_f32 v94, v94
  v_exp_f32 v95, v95
  v_exp_f32 v96, v96
  s_waitcnt lgkmcnt(0)
  v_readfirstlane_b32 s22, v13
  v_smfmac_f32_32x32x32_bf16 v[64:79], v[44:47], v[88:95], v8
  ds_read_b128 v[40:43], v5 offset:1536
  s_cmp_lt_u32 s22, s21
  s_cbranch_scc1 fa_poll1
fa_polled1:
  v_exp_f32 v97, v97
  v_exp_f32 v98, v98
  v_exp_f32 v99, v99
  v_exp_f32 v100, v100
  v_exp_f32 v101, v101
  v_mfma_f32_32x32x16_bf16 v[80:95], v[24:27], v[16:19], v[48:63]
  ds_read_b128 v[28:31], v1 offset:23552
  v_exp_f32 v102, v102
  v_exp_f32 v103, v103
  v_exp_f32 v104, v104
  v_exp_f32 v105, v105
  v_exp_f32 v106, v106
  v_smfmac_f32_32x32x32_bf16 v[64:79], v[36:39], v[96:103], v8
  ds_read_b128 v[32:35], v5 offset:2048
  v_exp_f32 v107, v107
  v_exp_f32 v108, v108
  v_exp_f32 v109, v109
  v_exp_f32 v110, v110
  v_exp_f32 v111, v111
  v_exp_f32 v80, v80
  s_waitcnt lgkmcnt(0)
  v_smfmac_f32_32x32x32_bf16 v[64:79], v[40:43], v[104:111], v8
  ds_read_b128 v[44:47], v5 offset:2560
  v_exp_f32 v81, v81
  v_exp_f32 v82, v82
  v_exp_f32 v83, v83
  v_exp_f32 v84, v84
  v_exp_f32 v85, v85
  v_mfma_f32_32x32x16_bf16 v[96:111], v[28:31], v[16:19], v[48:63]
  ds_read_b128 v[24:27], v1 offset:32768
  s_add_u32 m0, s18, 0
  s_add_u32 s19, s29, 0
  buffer_load_dwordx4 v1, s[8:11], s19 offen sc1 lds
  v_exp_f32 v86, v86
  v_exp_f32 v87, v87
  v_exp_f32 v88, v88
  v_exp_f32 v89, v89
  v_exp_f32 v90, v90
  v_smfmac_f32_32x32x32_bf16 v[64:79], v[32:35], v[80:87], v8
  ds_read_b128 v[36:39], v5 offset:3072
  v_exp_f32 v91, v91
  v_exp_f32 v92, v92
  v_exp_f32 v93, v93
  v_exp_f32 v94, v94
  v_exp_f32 v95, v95
  v_exp_f32 v96, v96
  s_waitcnt lgkmcnt(0)
  v_smfmac_f32_32x32x32_bf16 v[64:79], v[44:47], v[88:95], v8
  ds_read_b128 v[40:43], v5 offset:3584
  v_exp_f32 v97, v97
  v_exp_f32 v98, v98
  v_exp_f32 v99, v99
  v_exp_f32 v100, v100
  v_exp_f32 v101, v101
  v_mfma_f32_32x32x16_bf16 v[80:95], v[24:27], v[16:19], v[48:63]
  ds_read_b128 v[28:31], v1 offset:33792
  s_add_u32 m0, s18, 8192
  s_add_u32 s19, s29, 65536
  buffer_load_dwordx4 v1, s[8:11], s19 offen sc1 lds
  v_exp_f32 v102, v102
  v_exp_f32 v103, v103
  v_exp_f32 v104, v104
  v_exp_f32 v105, v105
  v_exp_f32 v106, v106
  v_smfmac_f32_32x32x32_bf16 v[64:79], v[36:39], v[96:103], v8
  ds_read_b128 v[32:35], v6 offset:0
  s_setprio 1
  s_add_u32 s29, s29, 8192
  s_cmp_lt_u32 s20, 5
  s_cselect_b32 s29, s29, 0x100000
  s_add_u32 s21, s21, 8
  s_add_u32 s20, s20, 1
  s_cmp_eq_u32 s20, 8
  v_exp_f32 v107, v107
  v_exp_f32 v108, v108
  v_exp_f32 v109, v109
  v_exp_f32 v110, v110
  v_exp_f32 v111, v111
  s_cbranch_scc1 fa_out
  v_exp_f32 v80, v80
  s_waitcnt lgkmcnt(0)
  v_smfmac_f32_32x32x32_bf16 v[64:79], v[40:43], v[104:111], v8
  ds_read_b128 v[44:47], v6 offset:512
  v_exp_f32 v81, v81
  v_exp_f32 v82, v82
  v_exp_f32 v83, v83
  v_exp_f32 v84, v84
  v_exp_f32 v85, v85
  v_mfma_f32_32x32x16_bf16 v[96:111], v[28:31], v[16:19], v[48:63]
  ds_read_b128 v[24:27], v1 offset:34816
  v_exp_f32 v86, v86
  v_exp_f32 v87, v87
  v_exp_f32 v88, v88
  v_exp_f32 v89, v89
  v_exp_f32 v90, v90
  v_smfmac_f32_32x32x32_bf16 v[64:79], v[32:35], v[80:87], v8
  ds_read_b128 v[36:39], v6 offset:1024
  s_cmp_eq_u32 s23, 0
  s_cbranch_scc1 fa_np20
  s_setprio 2
fa_np20:
  v_exp_f32 v91, v91
  v_exp_f32 v92, v92
  v_exp_f32 v93, v93
  v_exp_f32 v94, v94
  v_exp_f32 v95, v95
  v_exp_f32 v96, v96
  s_waitcnt lgkmcnt(0)
  v_smfmac_f32_32x32x32_bf16 v[64:79], v[44:47], v[88:95], v8
  ds_read_b128 v[40:43], v6 offset:1536
  v_exp_f32 v97, v97
  v_exp_f32 v98, v98
  v_exp_f32 v99, v99
  v_exp_f32 v100, v100
  v_exp_f32 v101, v101
  v_mfma_f32_32x32x16_bf16 v[80:95], v[24:27], v[16:19], v[48:63]
  ds_read_b128 v[28:31], v1 offset:35840
  v_exp_f32 v102, v102
  v_exp_f32 v103, v103
  v_exp_f32 v104, v104
  v_exp_f32 v105, v105
  v_exp_f32 v106, v106
  v_smfmac_f32_32x32x32_bf16 v[64:79], v[36:39], v[96:103], v8
  ds_read_b128 v[32:35], v6 offset:2048
  v_exp_f32 v107, v107
  v_exp_f32 v108, v108
  v_exp_f32 v109, v109
  v_exp_f32 v110, v110
  v_exp_f32 v111, v111
  v_exp_f32 v80, v80
  s_waitcnt lgkmcnt(0)
  v_smfmac_f32_32x32x32_bf16 v[64:79], v[40:43], v[104:111], v8
  ds_read_b128 v[44:47], v6 offset:2560
  v_exp_f32 v81, v81
  v_exp_f32 v82, v82
  v_exp_f32 v83, v83
  v_exp_f32 v84, v84
  v_exp_f32 v85, v85
  v_mfma_f32_32x32x16_bf16 v[96:111], v[28:31], v[16:19], v[48:63]
  ds_read_b128 v[24:27], v1 offset:36864
  v_exp_f32 v86, v86
  v_exp_f32 v87, v87
  v_exp_f32 v88, v88
  v_exp_f32 v89, v89
  v_exp_f32 v90, v90
  v_smfmac_f32_32x32x32_bf16 v[64:79], v[32:35], v[80:87], v8
  ds_read_b128 v[36:39], v6 offset:3072
  v_exp_f32 v91, v91
  v_exp_f32 v92, v92
  v_exp_f32 v93, v93
  v_exp_f32 v94, v94
  v_exp_f32 v95, v95
  v_exp_f32 v96, v96
  s_waitcnt lgkmcnt(0)
  v_smfmac_f32_32x32x32_bf16 v[64:79], v[44:47], v[88:95], v8
  ds_read_b128 v[40:43], v6 offset:3584
  v_exp_f32 v97, v97
  v_exp_f32 v98, v98
  v_exp_f32 v99, v99
  v_exp_f32 v100, v100
  v_exp_f32 v101, v101
  v_mfma_f32_32x32x16_bf16 v[80:95], v[24:27], v[16:19], v[48:63]
  ds_read_b128 v[28:31], v1 offset:37888
  s_waitcnt vmcnt(0)
  s_mov_b64 exec, 1
  ds_add_u32 v11, v12 offset:36
  s_mov_b64 exec, -1
  v_exp_f32 v102, v102
  v_exp_f32 v103, v103
  v_exp_f32 v104, v104
  v_exp_f32 v105, v105
  v_exp_f32 v106, v106
  v_smfmac_f32_32x32x32_bf16 v[64:79], v[36:39], v[96:103], v8
  ds_read_b128 v[32:35], v7 offset:0
  s_setprio 1
  v_exp_f32 v107, v107
  v_exp_f32 v108, v108
  v_exp_f32 v109, v109
  v_exp_f32 v110, v110
  v_exp_f32 v111, v111
  v_exp_f32 v80, v80
  s_waitcnt lgkmcnt(0)
  v_smfmac_f32_32x32x32_bf16 v[64:79], v[40:43], v[104:111], v8
  ds_read_b128 v[44:47], v7 offset:512
  v_exp_f32 v81, v81
  v_exp_f32 v82, v82
  v_exp_f32 v83, v83
  v_exp_f32 v84, v84
  v_exp_f32 v85, v85
  v_mfma_f32_32x32x16_bf16 v[96:111], v[28:31], v[16:19], v[48:63]
  ds_read_b128 v[24:27], v1 offset:38912
  ds_read_b32 v13, v11 offset:36
  v_exp_f32 v86, v86
  v_exp_f32 v87, v87
  v_exp_f32 v88, v88
  v_exp_f32 v89, v89
  v_exp_f32 v90, v90
  v_smfmac_f32_32x32x32_bf16 v[64:79], v[32:35], v[80:87], v8
  ds_read_b128 v[36:39], v7 offset:1024
  s_cmp_eq_u32 s23, 0
  s_cbranch_scc1 fa_np24
  s_setprio 2
fa_np24:
  v_exp_f32 v91, v91
  v_exp_f32 v92, v92
  v_exp_f32 v93, v93
  v_exp_f32 v94, v94
  v_exp_f32 v95, v95
  v_exp_f32 v96, v96
  s_waitcnt lgkmcnt(0)
  v_readfirstlane_b32 s22, v13
  v_smfmac_f32_32x32x32_bf16 v[64:79], v[44:47], v[88:95], v8
  ds_read_b128 v[40:43], v7 offset:1536
  s_cmp_lt_u32 s22, s21
  s_cbranch_scc1 fa_poll2
fa_polled2:
  v_exp_f32 v97, v97
  v_exp_f32 v98, v98
  v_exp_f32 v99, v99
  v_exp_f32 v100, v100
  v_exp_f32 v101, v101
  v_mfma_f32_32x32x16_bf16 v[80:95], v[24:27], v[16:19], v[48:63]
  ds_read_b128 v[28:31], v1 offset:39936
  v_exp_f32 v102, v102
  v_exp_f32 v103, v103
  v_exp_f32 v104, v104
  v_exp_f32 v105, v105
  v_exp_f32 v106, v106
  v_smfmac_f32_32x32x32_bf16 v[64:79], v[36:39], v[96:103], v8
  ds_read_b128 v[32:35], v7 offset:2048
  v_exp_f32 v107, v107
  v_exp_f32 v108, v108
  v_exp_f32 v109, v109
  v_exp_f32 v110, v110
  v_exp_f32 v111, v111
  v_exp_f32 v80, v80
  s_waitcnt lgkmcnt(0)
  v_smfmac_f32_32x32x32_bf16 v[64:79], v[40:43], v[104:111], v8
  ds_read_b128 v[44:47], v7 offset:2560
  v_exp_f32 v81, v81
  v_exp_f32 v82, v82
  v_exp_f32 v83, v83
  v_exp_f32 v84, v84
  v_exp_f32 v85, v85
  v_mfma_f32_32x32x16_bf16 v[96:111], v[28:31], v[16:19], v[48:63]
  ds_read_b128 v[24:27], v1 offset:0
  s_add_u32 m0, s18, 16384
  s_add_u32 s19, s29, 0
  buffer_load_dwordx4 v1, s[8:11], s19 offen sc1 lds
  v_exp_f32 v86, v86
  v_exp_f32 v87, v87
  v_exp_f32 v88, v88
  v_exp_f32 v89, v89
  v_exp_f32 v90, v90
  v_smfmac_f32_32x32x32_bf16 v[64:79], v[32:35], v[80:87], v8
  ds_read_b128 v[36:39], v7 offset:3072
  v_exp_f32 v91, v91
  v_exp_f32 v92, v92
  v_exp_f32 v93, v93
  v_exp_f32 v94, v94
  v_exp_f32 v95, v95
  v_exp_f32 v96, v96
  s_waitcnt lgkmcnt(0)
  v_smfmac_f32_32x32x32_bf16 v[64:79], v[44:47], v[88:95], v8
  ds_read_b128 v[40:43], v7 offset:3584
  v_exp_f32 v97, v97
  v_exp_f32 v98, v98
  v_exp_f32 v99, v99
  v_exp_f32 v100, v100
  v_exp_f32 v101, v101
  v_mfma_f32_32x32x16_bf16 v[80:95], v[24:27], v[16:19], v[48:63]
  ds_read_b128 v[28:31], v1 offset:1024
  s_add_u32 m0, s18, 24576
  s_add_u32 s19, s29, 65536
  buffer_load_dwordx4 v1, s[8:11], s19 offen sc1 lds
  v_exp_f32 v102, v102
  v_exp_f32 v103, v103
  v_exp_f32 v104, v104
  v_exp_f32 v105, v105
  v_exp_f32 v106, v106
  v_smfmac_f32_32x32x32_bf16 v[64:79], v[36:39], v[96:103], v8
  ds_read_b128 v[32:35], v2 offset:0
  s_setprio 1
  s_add_u32 s29, s29, 8192
  s_cmp_lt_u32 s20, 5
  s_cselect_b32 s29, s29, 0x100000
  s_add_u32 s21, s21, 8
  s_add_u32 s20, s20, 1
  v_exp_f32 v107, v107
  v_exp_f32 v108, v108
  v_exp_f32 v109, v109
  v_exp_f32 v110, v110
  v_exp_f32 v111, v111
  s_branch fa_loop
fa_out:
  s_waitcnt lgkmcnt(0)
  s_nop 0
  v_smfmac_f32_32x32x32_bf16 v[64:79], v[40:43], v[104:111], v8
  s_nop 7
  s_nop 3
  v_mov_b32 v73, v72
  s_nop 1
  v_permlane32_swap_b32 v72, v73
  s_mov_b32 s24, 0x5f800000
  v_cmp_gt_f32 vcc, s24, v72
  s_nop 3
  s_cmp_eq_u64 vcc, -1
  s_cbranch_scc0 fa_slow
fa_fin:
  s_lshl_b32 s17, s16, 15
  s_lshl_b32 s18, s6, 10
  s_add_u32 s17, s17, s18
  s_add_u32 s17, s17, 6291456
  v_rcp_f32 v9, v72
  s_lshl_b32 s19, s7, 8
  s_add_u32 s19, s19, 17899520
  v_mul_f32 v9, v9, v14
  v_mul_f32 v64, v64, v9
  v_mul_f32 v65, v65, v9
  v_mul_f32 v66, v66, v9
  v_mul_f32 v67, v67, v9
  v_mul_f32 v68, v68, v9
  v_mul_f32 v69, v69, v9
  v_mul_f32 v70, v70, v9
  v_mul_f32 v71, v71, v9
  v_cvt_pk_bf16_f32 v24, v64, v65
  v_cvt_pk_bf16_f32 v25, v66, v67
  v_cvt_pk_bf16_f32 v26, v68, v69
  v_cvt_pk_bf16_f32 v27, v70, v71
  buffer_store_dwordx4 v[24:27], v1, s[12:15], s17 offen sc1
  s_mov_b64 exec, 1
  ds_add_u32 v11, v12 offset:4
  s_mov_b64 exec, -1
  s_endpgm
fa_poll0:
  s_mov_b32 s97, 0x40000
fa_pollw0:
  ds_read_b32 v13, v11 offset:36
  s_sub_u32 s97, s97, 1
  s_cbranch_scc1 fa_pollw0_ok
  s_waitcnt lgkmcnt(0)
  v_readfirstlane_b32 s22, v13
  s_nop 1
  s_cmp_ge_u32 s22, s21
  s_cbranch_scc0 fa_pollw0
fa_pollw0_ok:
  s_waitcnt lgkmcnt(0)
  s_branch fa_polled0
fa_poll1:
  s_mov_b32 s97, 0x40000
fa_pollw1:
  ds_read_b32 v13, v11 offset:36
  s_sub_u32 s97, s97, 1
  s_cbranch_scc1 fa_pollw1_ok
  s_waitcnt lgkmcnt(0)
  v_readfirstlane_b32 s22, v13
  s_nop 1
  s_cmp_ge_u32 s22, s21
  s_cbranch_scc0 fa_pollw1
fa_pollw1_ok:
  s_waitcnt lgkmcnt(0)
  s_branch fa_polled1
fa_poll2:
  s_mov_b32 s97, 0x40000
fa_pollw2:
  ds_read_b32 v13, v11 offset:36
  s_sub_u32 s97, s97, 1
  s_cbranch_scc1 fa_pollw2_ok
  s_waitcnt lgkmcnt(0)
  v_readfirstlane_b32 s22, v13
  s_nop 1
  s_cmp_ge_u32 s22, s21
  s_cbranch_scc0 fa_pollw2
fa_pollw2_ok:
  s_waitcnt lgkmcnt(0)
  s_branch fa_polled2
fa_slow:
  s_waitcnt vmcnt(0)
  s_mov_b32 s20, 0
  v_mov_b32 v48, 0xff800000
fa_maxloop:
  buffer_load_dwordx4 v[24:27], v1, s[8:11], s20 offen sc1
  s_waitcnt vmcnt(0)
  v_mfma_f32_32x32x16_bf16 v[80:95], v[24:27], v[16:19], 0
  s_nop 7
  s_nop 3
  v_max3_f32 v48, v48, v80, v81
  v_max3_f32 v48, v48, v82, v83
  v_max3_f32 v48, v48, v84, v85
  v_max3_f32 v48, v48, v86, v87
  v_max3_f32 v48, v48, v88, v89
  v_max3_f32 v48, v48, v90, v91
  v_max3_f32 v48, v48, v92, v93
  v_max3_f32 v48, v48, v94, v95
  s_add_u32 s20, s20, 1024
  s_cmp_lt_u32 s20, 0x10000
  s_cbranch_scc1 fa_maxloop
  v_mov_b32 v9, v48
  v_mov_b32 v10, v9
  s_nop 1
  v_permlane32_swap_b32 v9, v10
  s_nop 1
  v_max_f32 v9, v9, v10
  v_sub_f32 v48, 0, v9
  v_sub_f32 v49, 0, v9
  v_mov_b64 v[50:51], v[48:49]
  v_mov_b64 v[52:53], v[48:49]
  v_mov_b64 v[54:55], v[48:49]
  v_mov_b64 v[56:57], v[48:49]
  v_mov_b64 v[58:59], v[48:49]
  v_mov_b64 v[60:61], v[48:49]
  v_mov_b64 v[62:63], v[48:49]
  v_mov_b32 v64, 0
  v_mov_b32 v65, 0
  v_mov_b32 v66, 0
  v_mov_b32 v67, 0
  v_mov_b32 v68, 0
  v_mov_b32 v69, 0
  v_mov_b32 v70, 0
  v_mov_b32 v71, 0
  v_mov_b32 v72, 0
  v_mov_b32 v73, 0
  v_mov_b32 v74, 0
  v_mov_b32 v75, 0
  v_mov_b32 v76, 0
  v_mov_b32 v77, 0
  v_mov_b32 v78, 0
  v_mov_b32 v79, 0
  v_and_b32 v9, 15, v0
  v_lshlrev_b32 v9, 4, v9
  v_lshrrev_b32 v10, 5, v0
  v_lshl_add_u32 v2, v10, 8, v9
  s_mov_b32 s20, 0
fa_pvloop:
  s_add_u32 s21, s20, 0x10000
  buffer_load_dwordx4 v[24:27], v1, s[8:11], s20 offen sc1
  s_mov_b32 exec_lo, 0xffff
  s_mov_b32 exec_hi, 0xffff
  buffer_load_dwordx4 v[32:35], v2, s[8:11], s21 offen sc1
  buffer_load_dwordx4 v[36:39], v2, s[8:11], s21 offen offset:512 sc1
  s_mov_b64 exec, -1
  s_waitcnt vmcnt(0)
  v_mfma_f32_32x32x16_bf16 v[80:95], v[24:27], v[16:19], v[48:63]
  s_nop 7
  s_nop 3
  v_exp_f32 v80, v80
  v_exp_f32 v81, v81
  v_exp_f32 v82, v82
  v_exp_f32 v83, v83
  v_exp_f32 v84, v84
  v_exp_f32 v85, v85
  v_exp_f32 v86, v86
  v_exp_f32 v87, v87
  v_exp_f32 v88, v88
  v_exp_f32 v89, v89
  v_exp_f32 v90, v90
  v_exp_f32 v91, v91
  v_exp_f32 v92, v92
  v_exp_f32 v93, v93
  v_exp_f32 v94, v94
  v_exp_f32 v95, v95
  s_nop 1
  v_smfmac_f32_32x32x32_bf16 v[64:79], v[32:35], v[80:87], v8
  v_smfmac_f32_32x32x32_bf16 v[64:79], v[36:39], v[88:95], v8
  s_add_u32 s20, s20, 1024
  s_cmp_lt_u32 s20, 0x10000
  s_cbranch_scc1 fa_pvloop
  s_nop 7
  s_nop 3
  v_mov_b32 v73, v72
  s_nop 1
  v_permlane32_swap_b32 v72, v73
  s_branch fa_fin
km_gemm:
  s_sub_u32 s3, s3, 8
  s_and_b32 s30, s2, 7
  s_lshr_b32 s31, s2, 3
  s_and_b32 s28, s30, 3
  s_lshl_b32 s28, s28, 3
  s_and_b32 s32, s31, 7
  s_add_u32 s28, s28, s32
  s_lshr_b32 s29, s30, 2
  s_lshl_b32 s29, s29, 2
  s_lshr_b32 s32, s31, 3
  s_add_u32 s29, s29, s32
  s_mov_b32 s61, 0
  s_setprio 0
  s_waitcnt lgkmcnt(0)
  s_mov_b32 s16, s64
  s_mov_b32 s17, s65
  s_mov_b32 s18, 0x200000
  s_mov_b32 s19, 0x20000
  s_mov_b32 s20, s66
  s_mov_b32 s21, s67
  s_mov_b32 s22, 0x180000
  s_mov_b32 s23, 0x20000
  s_mov_b32 s12, s86
  s_mov_b32 s13, s87
  s_mov_b32 s14, 0x1800000
  s_mov_b32 s15, 0x20000
  s_xor_b32 s46, s3, 3
  s_or_b32 s46, s46, s2
  v_lshlrev_b32 v8, 7, v0
  s_lshl_b32 s33, s2, 13
  s_mul_i32 s34, s2, 6144
  s_cmp_lg_u32 s46, 0
  s_cbranch_scc1 qc_nozero
  v_lshlrev_b32 v10, 8, v0
  v_mov_b32 v9, 0
  s_mov_b32 s40, 17891328
  s_mov_b32 s41, 17907712
  buffer_store_dword v9, v10, s[12:15], s40 offen sc0 sc1
  buffer_store_dword v9, v10, s[12:15], s41 offen sc0 sc1
  s_nop 0
  v_mov_b32 v10, 1
  s_waitcnt vmcnt(0)
  s_mov_b64 exec, 1
  global_store_dword v9, v10, s[84:85] sc0 sc1
  s_mov_b64 exec, -1
qc_nozero:
  s_cmp_eq_u32 s3, 0
  s_cbranch_scc0 qc_pf1
  buffer_load_dword v158, v8, s[16:19], s33 offen
qc_pf1:
  s_cmp_eq_u32 s3, 1
  s_cbranch_scc0 qc_pf2
  s_mov_b32 exec_hi, 0xffff
  buffer_load_dword v158, v8, s[20:23], s34 offen
  s_mov_b32 exec_hi, -1
qc_pf2:
  s_and_b32 s32, s3, 1
  s_lshl_b32 s32, s32, 12
  v_and_b32 v8, 31, v0
  v_lshlrev_b32 v9, 7, v8
  v_add_u32 v9, s32, v9
  v_add_u32 v9, 73728, v9
  v_bfe_u32 v8, v0, 1, 3
  v_lshrrev_b32 v10, 5, v0
  v_xor_b32 v8, v8, v10
  v_xor_b32 v10, 0, v8
  v_lshl_add_u32 v2, v10, 4, v9
  v_xor_b32 v10, 2, v8
  v_lshl_add_u32 v3, v10, 4, v9
  v_xor_b32 v10, 4, v8
  v_lshl_add_u32 v4, v10, 4, v9
  v_xor_b32 v10, 6, v8
  v_lshl_add_u32 v5, v10, 4, v9
  v_lshrrev_b32 v8, 5, v0
  v_mul_u32_u24 v6, 3072, v8
  v_bfe_u32 v8, v0, 2, 2
  v_lshl_add_u32 v6, v8, 7, v6
  v_bfe_u32 v8, v0, 3, 1
  s_lshr_b32 s32, s3, 1
  v_xor_b32 v8, s32, v8
  v_lshl_add_u32 v6, v8, 6, v6
  v_bfe_u32 v8, v0, 4, 1
  v_lshl_add_u32 v6, v8, 5, v6
  v_and_b32 v8, 1, v0
  v_lshl_add_u32 v6, v8, 4, v6
  v_bfe_u32 v8, v0, 1, 1
  v_lshl_add_u32 v6, v8, 3, v6
  v_add_u32 v7, 49152, v6
  v_add_u32 v14, 139264, v6
  s_barrier
  ds_read_b128 v[16:19], v2 offset:0
  ds_read_b64_tr_b16 v[20:21], v6 offset:0
  ds_read_b64_tr_b16 v[22:23], v6 offset:512
  ds_read_b64_tr_b16 v[24:25], v6 offset:1024
  ds_read_b64_tr_b16 v[26:27], v6 offset:1536
  ds_read_b64_tr_b16 v[28:29], v6 offset:2048
  ds_read_b64_tr_b16 v[30:31], v6 offset:2560
  ds_read_b128 v[32:35], v3 offset:0
  ds_read_b64_tr_b16 v[36:37], v6 offset:6144
  ds_read_b64_tr_b16 v[38:39], v6 offset:6656
  ds_read_b64_tr_b16 v[40:41], v6 offset:7168
  ds_read_b64_tr_b16 v[42:43], v6 offset:7680
  ds_read_b64_tr_b16 v[44:45], v6 offset:8192
  ds_read_b64_tr_b16 v[46:47], v6 offset:8704
  ds_read_b128 v[96:99], v4 offset:0
  ds_read_b64_tr_b16 v[100:101], v6 offset:12288
  ds_read_b64_tr_b16 v[102:103], v6 offset:12800
  ds_read_b64_tr_b16 v[104:105], v6 offset:13312
  ds_read_b64_tr_b16 v[106:107], v6 offset:13824
  ds_read_b64_tr_b16 v[108:109], v6 offset:14336
  ds_read_b64_tr_b16 v[110:111], v6 offset:14848
  s_waitcnt lgkmcnt(14)
  v_mfma_f32_32x32x16_bf16 v[64:79], v[24:27], v[16:19], 0
  v_mfma_f32_32x32x16_bf16 v[80:95], v[16:19], v[28:31], 0
  v_mfma_f32_32x32x16_bf16 v[48:63], v[20:23], v[16:19], 0
  ds_read_b128 v[16:19], v5 offset:0
  ds_read_b64_tr_b16 v[20:21], v6 offset:18432
  ds_read_b64_tr_b16 v[22:23], v6 offset:18944
  ds_read_b64_tr_b16 v[24:25], v6 offset:19456
  ds_read_b64_tr_b16 v[26:27], v6 offset:19968
  ds_read_b64_tr_b16 v[28:29], v6 offset:20480
  ds_read_b64_tr_b16 v[30:31], v6 offset:20992
  s_waitcnt lgkmcnt(14)
  v_mfma_f32_32x32x16_bf16 v[64:79], v[40:43], v[32:35], v[64:79]
  v_mfma_f32_32x32x16_bf16 v[80:95], v[32:35], v[44:47], v[80:95]
  v_mfma_f32_32x32x16_bf16 v[48:63], v[36:39], v[32:35], v[48:63]
  s_waitcnt lgkmcnt(0)
  s_barrier
  ds_read_b128 v[32:35], v2 offset:8192
  ds_read_b64_tr_b16 v[36:37], v6 offset:24576
  ds_read_b64_tr_b16 v[38:39], v6 offset:25088
  ds_read_b64_tr_b16 v[40:41], v6 offset:25600
  ds_read_b64_tr_b16 v[42:43], v6 offset:26112
  ds_read_b64_tr_b16 v[44:45], v6 offset:26624
  ds_read_b64_tr_b16 v[46:47], v6 offset:27136
  v_mfma_f32_32x32x16_bf16 v[64:79], v[104:107], v[96:99], v[64:79]
  v_mfma_f32_32x32x16_bf16 v[80:95], v[96:99], v[108:111], v[80:95]
  v_mfma_f32_32x32x16_bf16 v[48:63], v[100:103], v[96:99], v[48:63]
  ds_read_b128 v[96:99], v3 offset:8192
  ds_read_b64_tr_b16 v[100:101], v6 offset:30720
  ds_read_b64_tr_b16 v[102:103], v6 offset:31232
  ds_read_b64_tr_b16 v[104:105], v6 offset:31744
  ds_read_b64_tr_b16 v[106:107], v6 offset:32256
  ds_read_b64_tr_b16 v[108:109], v6 offset:32768
  ds_read_b64_tr_b16 v[110:111], v6 offset:33280
  s_waitcnt lgkmcnt(14)
  v_mfma_f32_32x32x16_bf16 v[64:79], v[24:27], v[16:19], v[64:79]
  v_mfma_f32_32x32x16_bf16 v[80:95], v[16:19], v[28:31], v[80:95]
  v_mfma_f32_32x32x16_bf16 v[48:63], v[20:23], v[16:19], v[48:63]
  ds_read_b128 v[16:19], v4 offset:8192
  ds_read_b64_tr_b16 v[20:21], v6 offset:36864
  ds_read_b64_tr_b16 v[22:23], v6 offset:37376
  ds_read_b64_tr_b16 v[24:25], v6 offset:37888
  ds_read_b64_tr_b16 v[26:27], v6 offset:38400
  ds_read_b64_tr_b16 v[28:29], v6 offset:38912
  ds_read_b64_tr_b16 v[30:31], v6 offset:39424
  s_waitcnt lgkmcnt(14)
  v_mfma_f32_32x32x16_bf16 v[64:79], v[40:43], v[32:35], v[64:79]
  v_mfma_f32_32x32x16_bf16 v[80:95], v[32:35], v[44:47], v[80:95]
  v_mfma_f32_32x32x16_bf16 v[48:63], v[36:39], v[32:35], v[48:63]
  ds_read_b128 v[32:35], v5 offset:8192
  ds_read_b64_tr_b16 v[36:37], v6 offset:43008
  ds_read_b64_tr_b16 v[38:39], v6 offset:43520
  ds_read_b64_tr_b16 v[40:41], v6 offset:44032
  ds_read_b64_tr_b16 v[42:43], v6 offset:44544
  ds_read_b64_tr_b16 v[44:45], v6 offset:45056
  ds_read_b64_tr_b16 v[46:47], v6 offset:45568
  s_waitcnt lgkmcnt(14)
  v_mfma_f32_32x32x16_bf16 v[64:79], v[104:107], v[96:99], v[64:79]
  v_mfma_f32_32x32x16_bf16 v[80:95], v[96:99], v[108:111], v[80:95]
  v_mfma_f32_32x32x16_bf16 v[48:63], v[100:103], v[96:99], v[48:63]
  s_waitcnt lgkmcnt(0)
  s_barrier
  ds_read_b128 v[96:99], v2 offset:16384
  ds_read_b64_tr_b16 v[100:101], v7 offset:0
  ds_read_b64_tr_b16 v[102:103], v7 offset:512
  ds_read_b64_tr_b16 v[104:105], v7 offset:1024
  ds_read_b64_tr_b16 v[106:107], v7 offset:1536
  ds_read_b64_tr_b16 v[108:109], v7 offset:2048
  ds_read_b64_tr_b16 v[110:111], v7 offset:2560
  v_mfma_f32_32x32x16_bf16 v[64:79], v[24:27], v[16:19], v[64:79]
  v_mfma_f32_32x32x16_bf16 v[80:95], v[16:19], v[28:31], v[80:95]
  v_mfma_f32_32x32x16_bf16 v[48:63], v[20:23], v[16:19], v[48:63]
  ds_read_b128 v[16:19], v3 offset:16384
  ds_read_b64_tr_b16 v[20:21], v7 offset:6144
  ds_read_b64_tr_b16 v[22:23], v7 offset:6656
  ds_read_b64_tr_b16 v[24:25], v7 offset:7168
  ds_read_b64_tr_b16 v[26:27], v7 offset:7680
  ds_read_b64_tr_b16 v[28:29], v7 offset:8192
  ds_read_b64_tr_b16 v[30:31], v7 offset:8704
  s_waitcnt lgkmcnt(14)
  v_mfma_f32_32x32x16_bf16 v[64:79], v[40:43], v[32:35], v[64:79]
  v_mfma_f32_32x32x16_bf16 v[80:95], v[32:35], v[44:47], v[80:95]
  v_mfma_f32_32x32x16_bf16 v[48:63], v[36:39], v[32:35], v[48:63]
  ds_read_b128 v[32:35], v4 offset:16384
  ds_read_b64_tr_b16 v[36:37], v7 offset:12288
  ds_read_b64_tr_b16 v[38:39], v7 offset:12800
  ds_read_b64_tr_b16 v[40:41], v7 offset:13312
  ds_read_b64_tr_b16 v[42:43], v7 offset:13824
  ds_read_b64_tr_b16 v[44:45], v7 offset:14336
  ds_read_b64_tr_b16 v[46:47], v7 offset:14848
  s_waitcnt lgkmcnt(14)
  v_mfma_f32_32x32x16_bf16 v[64:79], v[104:107], v[96:99], v[64:79]
  v_mfma_f32_32x32x16_bf16 v[80:95], v[96:99], v[108:111], v[80:95]
  v_mfma_f32_32x32x16_bf16 v[48:63], v[100:103], v[96:99], v[48:63]
  ds_read_b128 v[96:99], v5 offset:16384
  ds_read_b64_tr_b16 v[100:101], v7 offset:18432
  ds_read_b64_tr_b16 v[102:103], v7 offset:18944
  ds_read_b64_tr_b16 v[104:105], v7 offset:19456
  ds_read_b64_tr_b16 v[106:107], v7 offset:19968
  ds_read_b64_tr_b16 v[108:109], v7 offset:20480
  ds_read_b64_tr_b16 v[110:111], v7 offset:20992
  s_waitcnt lgkmcnt(14)
  v_mfma_f32_32x32x16_bf16 v[64:79], v[24:27], v[16:19], v[64:79]
  v_mfma_f32_32x32x16_bf16 v[80:95], v[16:19], v[28:31], v[80:95]
  v_mfma_f32_32x32x16_bf16 v[48:63], v[20:23], v[16:19], v[48:63]
  s_waitcnt lgkmcnt(0)
  s_barrier
  ds_read_b128 v[16:19], v2 offset:24576
  ds_read_b64_tr_b16 v[20:21], v6 offset:0
  ds_read_b64_tr_b16 v[22:23], v6 offset:512
  ds_read_b64_tr_b16 v[24:25], v6 offset:1024
  ds_read_b64_tr_b16 v[26:27], v6 offset:1536
  ds_read_b64_tr_b16 v[28:29], v6 offset:2048
  ds_read_b64_tr_b16 v[30:31], v6 offset:2560
  v_mfma_f32_32x32x16_bf16 v[64:79], v[40:43], v[32:35], v[64:79]
  v_mfma_f32_32x32x16_bf16 v[80:95], v[32:35], v[44:47], v[80:95]
  v_mfma_f32_32x32x16_bf16 v[48:63], v[36:39], v[32:35], v[48:63]
  ds_read_b128 v[32:35], v3 offset:24576
  ds_read_b64_tr_b16 v[36:37], v6 offset:6144
  ds_read_b64_tr_b16 v[38:39], v6 offset:6656
  ds_read_b64_tr_b16 v[40:41], v6 offset:7168
  ds_read_b64_tr_b16 v[42:43], v6 offset:7680
  ds_read_b64_tr_b16 v[44:45], v6 offset:8192
  ds_read_b64_tr_b16 v[46:47], v6 offset:8704
  s_waitcnt lgkmcnt(14)
  v_mfma_f32_32x32x16_bf16 v[64:79], v[104:107], v[96:99], v[64:79]
  v_mfma_f32_32x32x16_bf16 v[80:95], v[96:99], v[108:111], v[80:95]
  v_mfma_f32_32x32x16_bf16 v[48:63], v[100:103], v[96:99], v[48:63]
  ds_read_b128 v[96:99], v4 offset:24576
  ds_read_b64_tr_b16 v[100:101], v6 offset:12288
  ds_read_b64_tr_b16 v[102:103], v6 offset:12800
  ds_read_b64_tr_b16 v[104:105], v6 offset:13312
  ds_read_b64_tr_b16 v[106:107], v6 offset:13824
  ds_read_b64_tr_b16 v[108:109], v6 offset:14336
  ds_read_b64_tr_b16 v[110:111], v6 offset:14848
  s_waitcnt lgkmcnt(14)
  v_mfma_f32_32x32x16_bf16 v[64:79], v[24:27], v[16:19], v[64:79]
  v_mfma_f32_32x32x16_bf16 v[80:95], v[16:19], v[28:31], v[80:95]
  v_mfma_f32_32x32x16_bf16 v[48:63], v[20:23], v[16:19], v[48:63]
  ds_read_b128 v[16:19], v5 offset:24576
  ds_read_b64_tr_b16 v[20:21], v6 offset:18432
  ds_read_b64_tr_b16 v[22:23], v6 offset:18944
  ds_read_b64_tr_b16 v[24:25], v6 offset:19456
  ds_read_b64_tr_b16 v[26:27], v6 offset:19968
  ds_read_b64_tr_b16 v[28:29], v6 offset:20480
  ds_read_b64_tr_b16 v[30:31], v6 offset:20992
  s_waitcnt lgkmcnt(14)
  v_mfma_f32_32x32x16_bf16 v[64:79], v[40:43], v[32:35], v[64:79]
  v_mfma_f32_32x32x16_bf16 v[80:95], v[32:35], v[44:47], v[80:95]
  v_mfma_f32_32x32x16_bf16 v[48:63], v[36:39], v[32:35], v[48:63]
  s_waitcnt lgkmcnt(0)
  s_barrier
  ds_read_b128 v[32:35], v2 offset:32768
  ds_read_b64_tr_b16 v[36:37], v6 offset:24576
  ds_read_b64_tr_b16 v[38:39], v6 offset:25088
  ds_read_b64_tr_b16 v[40:41], v6 offset:25600
  ds_read_b64_tr_b16 v[42:43], v6 offset:26112
  ds_read_b64_tr_b16 v[44:45], v6 offset:26624
  ds_read_b64_tr_b16 v[46:47], v6 offset:27136
  v_mfma_f32_32x32x16_bf16 v[64:79], v[104:107], v[96:99], v[64:79]
  v_mfma_f32_32x32x16_bf16 v[80:95], v[96:99], v[108:111], v[80:95]
  v_mfma_f32_32x32x16_bf16 v[48:63], v[100:103], v[96:99], v[48:63]
  ds_read_b128 v[96:99], v3 offset:32768
  ds_read_b64_tr_b16 v[100:101], v6 offset:30720
  ds_read_b64_tr_b16 v[102:103], v6 offset:31232
  ds_read_b64_tr_b16 v[104:105], v6 offset:31744
  ds_read_b64_tr_b16 v[106:107], v6 offset:32256
  ds_read_b64_tr_b16 v[108:109], v6 offset:32768
  ds_read_b64_tr_b16 v[110:111], v6 offset:33280
  s_waitcnt lgkmcnt(14)
  v_mfma_f32_32x32x16_bf16 v[64:79], v[24:27], v[16:19], v[64:79]
  v_mfma_f32_32x32x16_bf16 v[80:95], v[16:19], v[28:31], v[80:95]
  v_mfma_f32_32x32x16_bf16 v[48:63], v[20:23], v[16:19], v[48:63]
  ds_read_b128 v[16:19], v4 offset:32768
  ds_read_b64_tr_b16 v[20:21], v6 offset:36864
  ds_read_b64_tr_b16 v[22:23], v6 offset:37376
  ds_read_b64_tr_b16 v[24:25], v6 offset:37888
  ds_read_b64_tr_b16 v[26:27], v6 offset:38400
  ds_read_b64_tr_b16 v[28:29], v6 offset:38912
  ds_read_b64_tr_b16 v[30:31], v6 offset:39424
  s_waitcnt lgkmcnt(14)
  v_mfma_f32_32x32x16_bf16 v[64:79], v[40:43], v[32:35], v[64:79]
  v_mfma_f32_32x32x16_bf16 v[80:95], v[32:35], v[44:47], v[80:95]
  v_mfma_f32_32x32x16_bf16 v[48:63], v[36:39], v[32:35], v[48:63]
  ds_read_b128 v[32:35], v5 offset:32768
  ds_read_b64_tr_b16 v[36:37], v6 offset:43008
  ds_read_b64_tr_b16 v[38:39], v6 offset:43520
  ds_read_b64_tr_b16 v[40:41], v6 offset:44032
  ds_read_b64_tr_b16 v[42:43], v6 offset:44544
  ds_read_b64_tr_b16 v[44:45], v6 offset:45056
  ds_read_b64_tr_b16 v[46:47], v6 offset:45568
  s_waitcnt lgkmcnt(14)
  v_mfma_f32_32x32x16_bf16 v[64:79], v[104:107], v[96:99], v[64:79]
  v_mfma_f32_32x32x16_bf16 v[80:95], v[96:99], v[108:111], v[80:95]
  v_mfma_f32_32x32x16_bf16 v[48:63], v[100:103], v[96:99], v[48:63]
  s_waitcnt lgkmcnt(0)
  s_barrier
  ds_read_b128 v[96:99], v2 offset:40960
  ds_read_b64_tr_b16 v[100:101], v7 offset:0
  ds_read_b64_tr_b16 v[102:103], v7 offset:512
  ds_read_b64_tr_b16 v[104:105], v7 offset:1024
  ds_read_b64_tr_b16 v[106:107], v7 offset:1536
  ds_read_b64_tr_b16 v[108:109], v7 offset:2048
  ds_read_b64_tr_b16 v[110:111], v7 offset:2560
  v_mfma_f32_32x32x16_bf16 v[64:79], v[24:27], v[16:19], v[64:79]
  v_mfma_f32_32x32x16_bf16 v[80:95], v[16:19], v[28:31], v[80:95]
  v_mfma_f32_32x32x16_bf16 v[48:63], v[20:23], v[16:19], v[48:63]
  ds_read_b128 v[16:19], v3 offset:40960
  ds_read_b64_tr_b16 v[20:21], v7 offset:6144
  ds_read_b64_tr_b16 v[22:23], v7 offset:6656
  ds_read_b64_tr_b16 v[24:25], v7 offset:7168
  ds_read_b64_tr_b16 v[26:27], v7 offset:7680
  ds_read_b64_tr_b16 v[28:29], v7 offset:8192
  ds_read_b64_tr_b16 v[30:31], v7 offset:8704
  s_waitcnt lgkmcnt(14)
  v_mfma_f32_32x32x16_bf16 v[64:79], v[40:43], v[32:35], v[64:79]
  v_mfma_f32_32x32x16_bf16 v[80:95], v[32:35], v[44:47], v[80:95]
  v_mfma_f32_32x32x16_bf16 v[48:63], v[36:39], v[32:35], v[48:63]
  ds_read_b128 v[32:35], v4 offset:40960
  ds_read_b64_tr_b16 v[36:37], v7 offset:12288
  ds_read_b64_tr_b16 v[38:39], v7 offset:12800
  ds_read_b64_tr_b16 v[40:41], v7 offset:13312
  ds_read_b64_tr_b16 v[42:43], v7 offset:13824
  ds_read_b64_tr_b16 v[44:45], v7 offset:14336
  ds_read_b64_tr_b16 v[46:47], v7 offset:14848
  s_waitcnt lgkmcnt(14)
  v_mfma_f32_32x32x16_bf16 v[64:79], v[104:107], v[96:99], v[64:79]
  v_mfma_f32_32x32x16_bf16 v[80:95], v[96:99], v[108:111], v[80:95]
  v_mfma_f32_32x32x16_bf16 v[48:63], v[100:103], v[96:99], v[48:63]
  s_mov_b32 s24, s72
  s_mov_b32 s25, s73
  s_mov_b32 s26, 0x1c0000
  s_mov_b32 s27, 0x20000
  s_cmp_eq_u32 s3, 2
  s_cbranch_scc0 qc_pfm
  v_lshlrev_b32 v112, 7, v0
  s_mul_i32 s37, s2, 7168
  s_mov_b32 exec_hi, 0xffffff
  buffer_load_dword v159, v112, s[24:27], s37 offen
  s_mov_b32 exec_hi, -1
qc_pfm:
  ds_read_b128 v[96:99], v5 offset:40960
  ds_read_b64_tr_b16 v[100:101], v7 offset:18432
  ds_read_b64_tr_b16 v[102:103], v7 offset:18944
  ds_read_b64_tr_b16 v[104:105], v7 offset:19456
  ds_read_b64_tr_b16 v[106:107], v7 offset:19968
  ds_read_b64_tr_b16 v[108:109], v7 offset:20480
  ds_read_b64_tr_b16 v[110:111], v7 offset:20992
  s_waitcnt lgkmcnt(14)
  v_mfma_f32_32x32x16_bf16 v[64:79], v[24:27], v[16:19], v[64:79]
  v_mfma_f32_32x32x16_bf16 v[80:95], v[16:19], v[28:31], v[80:95]
  v_mfma_f32_32x32x16_bf16 v[48:63], v[20:23], v[16:19], v[48:63]
  s_waitcnt lgkmcnt(0)
  s_barrier
  ds_read_b128 v[16:19], v2 offset:49152
  ds_read_b64_tr_b16 v[20:21], v6 offset:0
  ds_read_b64_tr_b16 v[22:23], v6 offset:512
  ds_read_b64_tr_b16 v[24:25], v6 offset:1024
  ds_read_b64_tr_b16 v[26:27], v6 offset:1536
  ds_read_b64_tr_b16 v[28:29], v6 offset:2048
  ds_read_b64_tr_b16 v[30:31], v6 offset:2560
  v_mfma_f32_32x32x16_bf16 v[64:79], v[40:43], v[32:35], v[64:79]
  v_mfma_f32_32x32x16_bf16 v[80:95], v[32:35], v[44:47], v[80:95]
  v_mfma_f32_32x32x16_bf16 v[48:63], v[36:39], v[32:35], v[48:63]
  ds_read_b128 v[32:35], v3 offset:49152
  ds_read_b64_tr_b16 v[36:37], v6 offset:6144
  ds_read_b64_tr_b16 v[38:39], v6 offset:6656
  ds_read_b64_tr_b16 v[40:41], v6 offset:7168
  ds_read_b64_tr_b16 v[42:43], v6 offset:7680
  ds_read_b64_tr_b16 v[44:45], v6 offset:8192
  ds_read_b64_tr_b16 v[46:47], v6 offset:8704
  s_waitcnt lgkmcnt(14)
  v_mfma_f32_32x32x16_bf16 v[64:79], v[104:107], v[96:99], v[64:79]
  v_mfma_f32_32x32x16_bf16 v[80:95], v[96:99], v[108:111], v[80:95]
  v_mfma_f32_32x32x16_bf16 v[48:63], v[100:103], v[96:99], v[48:63]
  ds_read_b128 v[96:99], v4 offset:49152
  ds_read_b64_tr_b16 v[100:101], v6 offset:12288
  ds_read_b64_tr_b16 v[102:103], v6 offset:12800
  ds_read_b64_tr_b16 v[104:105], v6 offset:13312
  ds_read_b64_tr_b16 v[106:107], v6 offset:13824
  ds_read_b64_tr_b16 v[108:109], v6 offset:14336
  ds_read_b64_tr_b16 v[110:111], v6 offset:14848
  s_waitcnt lgkmcnt(14)
  v_mfma_f32_32x32x16_bf16 v[64:79], v[24:27], v[16:19], v[64:79]
  v_mfma_f32_32x32x16_bf16 v[80:95], v[16:19], v[28:31], v[80:95]
  v_mfma_f32_32x32x16_bf16 v[48:63], v[20:23], v[16:19], v[48:63]
  ds_read_b128 v[16:19], v5 offset:49152
  ds_read_b64_tr_b16 v[20:21], v6 offset:18432
  ds_read_b64_tr_b16 v[22:23], v6 offset:18944
  ds_read_b64_tr_b16 v[24:25], v6 offset:19456
  ds_read_b64_tr_b16 v[26:27], v6 offset:19968
  ds_read_b64_tr_b16 v[28:29], v6 offset:20480
  ds_read_b64_tr_b16 v[30:31], v6 offset:20992
  s_waitcnt lgkmcnt(14)
  v_mfma_f32_32x32x16_bf16 v[64:79], v[40:43], v[32:35], v[64:79]
  v_mfma_f32_32x32x16_bf16 v[80:95], v[32:35], v[44:47], v[80:95]
  v_mfma_f32_32x32x16_bf16 v[48:63], v[36:39], v[32:35], v[48:63]
  s_waitcnt lgkmcnt(0)
  s_barrier
  ds_read_b128 v[32:35], v2 offset:57344
  ds_read_b64_tr_b16 v[36:37], v6 offset:24576
  ds_read_b64_tr_b16 v[38:39], v6 offset:25088
  ds_read_b64_tr_b16 v[40:41], v6 offset:25600
  ds_read_b64_tr_b16 v[42:43], v6 offset:26112
  ds_read_b64_tr_b16 v[44:45], v6 offset:26624
  ds_read_b64_tr_b16 v[46:47], v6 offset:27136
  v_mfma_f32_32x32x16_bf16 v[64:79], v[104:107], v[96:99], v[64:79]
  v_mfma_f32_32x32x16_bf16 v[80:95], v[96:99], v[108:111], v[80:95]
  v_mfma_f32_32x32x16_bf16 v[48:63], v[100:103], v[96:99], v[48:63]
  s_setprio 2
  v_mov_b32 v11, 159744
  v_mov_b32 v12, 1
  ds_read_b128 v[96:99], v3 offset:57344
  ds_read_b64_tr_b16 v[100:101], v6 offset:30720
  ds_read_b64_tr_b16 v[102:103], v6 offset:31232
  ds_read_b64_tr_b16 v[104:105], v6 offset:31744
  ds_read_b64_tr_b16 v[106:107], v6 offset:32256
  ds_read_b64_tr_b16 v[108:109], v6 offset:32768
  ds_read_b64_tr_b16 v[110:111], v6 offset:33280
  s_waitcnt lgkmcnt(14)
  v_mfma_f32_32x32x16_bf16 v[64:79], v[24:27], v[16:19], v[64:79]
  v_mfma_f32_32x32x16_bf16 v[80:95], v[16:19], v[28:31], v[80:95]
  v_mfma_f32_32x32x16_bf16 v[48:63], v[20:23], v[16:19], v[48:63]
  ds_read_b128 v[16:19], v4 offset:57344
  ds_read_b64_tr_b16 v[20:21], v6 offset:36864
  ds_read_b64_tr_b16 v[22:23], v6 offset:37376
  ds_read_b64_tr_b16 v[24:25], v6 offset:37888
  ds_read_b64_tr_b16 v[26:27], v6 offset:38400
  ds_read_b64_tr_b16 v[28:29], v6 offset:38912
  ds_read_b64_tr_b16 v[30:31], v6 offset:39424
  s_waitcnt lgkmcnt(14)
  v_mfma_f32_32x32x16_bf16 v[64:79], v[40:43], v[32:35], v[64:79]
  v_mfma_f32_32x32x16_bf16 v[80:95], v[32:35], v[44:47], v[80:95]
  v_mfma_f32_32x32x16_bf16 v[48:63], v[36:39], v[32:35], v[48:63]
  s_lshl_b32 s32, s28, 1
  s_and_b32 s33, s3, 1
  s_add_u32 s32, s32, s33
  s_lshl_b32 s33, s32, 10
  s_lshr_b32 s36, s3, 1
  s_lshl_b32 s35, s29, 1
  s_add_u32 s35, s35, s36
  s_lshl_b32 s34, s35, 17
  s_add_u32 s40, s33, s34
  s_add_u32 s40, s40, 0
  s_add_u32 s41, s40, 0x10000
  s_add_u32 s35, s29, 1
  s_and_b32 s35, s35, 7
  s_lshl_b32 s35, s35, 1
  s_add_u32 s35, s35, s36
  s_lshl_b32 s34, s35, 18
  s_add_u32 s42, s33, s34
  s_add_u32 s42, s42, 2097152
  s_add_u32 s43, s42, 0x20000
  s_add_u32 s35, s29, 2
  s_and_b32 s35, s35, 7
  s_lshl_b32 s35, s35, 1
  s_add_u32 s35, s35, s36
  s_lshl_b32 s34, s35, 18
  s_add_u32 s44, s33, s34
  s_add_u32 s44, s44, 2162688
  s_mov_b32 s45, 0x3eb8aa3b
  ds_read_b128 v[32:35], v5 offset:57344
  ds_read_b64_tr_b16 v[36:37], v6 offset:43008
  ds_read_b64_tr_b16 v[38:39], v6 offset:43520
  ds_read_b64_tr_b16 v[40:41], v6 offset:44032
  ds_read_b64_tr_b16 v[42:43], v6 offset:44544
  ds_read_b64_tr_b16 v[44:45], v6 offset:45056
  ds_read_b64_tr_b16 v[46:47], v6 offset:45568
  s_waitcnt lgkmcnt(14)
  v_mfma_f32_32x32x16_bf16 v[64:79], v[104:107], v[96:99], v[64:79]
  v_mfma_f32_32x32x16_bf16 v[80:95], v[96:99], v[108:111], v[80:95]
  v_mfma_f32_32x32x16_bf16 v[48:63], v[100:103], v[96:99], v[48:63]
  v_lshlrev_b32 v112, 4, v0
  v_and_b32 v8, 0x33, v0
  v_bfe_u32 v9, v0, 2, 1
  v_lshl_or_b32 v8, v9, 3, v8
  v_bfe_u32 v9, v0, 3, 1
  v_lshl_or_b32 v8, v9, 2, v8
  v_lshlrev_b32 v113, 4, v8
  v_and_b32 v8, 15, v0
  v_lshlrev_b32 v8, 4, v8
  v_lshrrev_b32 v9, 5, v0
  v_lshl_add_u32 v8, v9, 8, v8
  v_bfe_u32 v9, v0, 4, 1
  v_lshl_add_u32 v114, v9, 17, v8
  s_waitcnt lgkmcnt(7)
  v_mfma_f32_32x32x16_bf16 v[64:79], v[24:27], v[16:19], v[64:79]
  v_mfma_f32_32x32x16_bf16 v[80:95], v[16:19], v[28:31], v[80:95]
  v_mfma_f32_32x32x16_bf16 v[48:63], v[20:23], v[16:19], v[48:63]
  s_waitcnt lgkmcnt(0)
  v_mfma_f32_32x32x16_bf16 v[64:79], v[40:43], v[32:35], v[64:79]
  v_mfma_f32_32x32x16_bf16 v[80:95], v[32:35], v[44:47], v[80:95]
  v_mfma_f32_32x32x16_bf16 v[48:63], v[36:39], v[32:35], v[48:63]
  s_mov_b64 exec, 1
  ds_add_u32 v11, v12 offset:56
  s_mov_b64 exec, -1
  s_nop 7
  s_nop 1
  v_cvt_pk_bf16_f32 v116, v64, v65
  v_cvt_pk_bf16_f32 v117, v66, v67
  v_cvt_pk_bf16_f32 v118, v68, v69
  v_cvt_pk_bf16_f32 v119, v70, v71
  buffer_store_dwordx4 v[116:119], v113, s[12:15], s42 offen sc1
  v_cvt_pk_bf16_f32 v120, v72, v73
  v_cvt_pk_bf16_f32 v121, v74, v75
  v_cvt_pk_bf16_f32 v122, v76, v77
  v_cvt_pk_bf16_f32 v123, v78, v79
  buffer_store_dwordx4 v[120:123], v113, s[12:15], s43 offen sc1
  v_cvt_pk_bf16_f32 v124, v80, v81
  v_cvt_pk_bf16_f32 v125, v82, v83
  v_cvt_pk_bf16_f32 v126, v84, v85
  v_cvt_pk_bf16_f32 v127, v86, v87
  buffer_store_dwordx4 v[124:127], v114, s[12:15], s44 offen offset:0 sc1
  v_cvt_pk_bf16_f32 v128, v88, v89
  v_cvt_pk_bf16_f32 v129, v90, v91
  v_cvt_pk_bf16_f32 v130, v92, v93
  v_cvt_pk_bf16_f32 v131, v94, v95
  buffer_store_dwordx4 v[128:131], v114, s[12:15], s44 offen offset:512 sc1
  v_mul_f32 v48, s45, v48
  v_mul_f32 v49, s45, v49
  v_mul_f32 v50, s45, v50
  v_mul_f32 v51, s45, v51
  v_mul_f32 v52, s45, v52
  v_mul_f32 v53, s45, v53
  v_mul_f32 v54, s45, v54
  v_mul_f32 v55, s45, v55
  v_cvt_pk_bf16_f32 v16, v48, v49
  v_cvt_pk_bf16_f32 v17, v50, v51
  v_cvt_pk_bf16_f32 v18, v52, v53
  v_cvt_pk_bf16_f32 v19, v54, v55
  buffer_store_dwordx4 v[16:19], v112, s[12:15], s40 offen sc1
  v_mul_f32 v56, s45, v56
  v_mul_f32 v57, s45, v57
  v_mul_f32 v58, s45, v58
  v_mul_f32 v59, s45, v59
  v_mul_f32 v60, s45, v60
  v_mul_f32 v61, s45, v61
  v_mul_f32 v62, s45, v62
  v_mul_f32 v63, s45, v63
  v_cvt_pk_bf16_f32 v20, v56, v57
  v_cvt_pk_bf16_f32 v21, v58, v59
  v_cvt_pk_bf16_f32 v22, v60, v61
  v_cvt_pk_bf16_f32 v23, v62, v63
  buffer_store_dwordx4 v[20:23], v112, s[12:15], s41 offen sc1
  v_mov_b32 v8, 159744
  v_mov_b32 v9, 1
  s_lshl_b32 s39, s29, 2
  s_lshr_b32 s40, s28, 3
  s_add_u32 s39, s39, s40
  s_lshl_b32 s39, s39, 8
  s_add_u32 s39, s39, 17915904
  s_lshr_b32 s40, s2, 3
  s_lshl_b32 s40, s40, 8
  s_add_u32 s40, s40, 17907712
  s_waitcnt vmcnt(0)
  s_mov_b64 exec, 1
  ds_add_rtn_u32 v10, v8, v9 offset:52
  s_waitcnt lgkmcnt(0)
  v_readfirstlane_b32 s37, v10
  s_nop 1
  s_cmp_lg_u32 s37, 3
  s_cbranch_scc1 qc_nosig
  buffer_atomic_add v9, off, s[12:15], s39 sc1
  buffer_atomic_add v9, off, s[12:15], s40 sc1
qc_nosig:
  s_mov_b64 exec, -1
  s_mov_b32 s6, 53248
  s_cmp_eq_u32 s3, 1
  s_cselect_b32 s6, 63488, s6
  s_cmp_eq_u32 s3, 2
  s_cselect_b32 s6, 139264, s6
  s_cmp_eq_u32 s3, 3
  s_cselect_b32 s6, 149504, s6
  s_and_b32 s4, s28, 1
  s_lshl_b32 s4, s4, 2
  s_add_u32 s4, s4, 3
  s_cmp_gt_u32 s29, s4
  s_cselect_b32 s5, 1, 0
  s_sub_u32 s5, s29, s5
  s_mov_b32 s32, 0
  s_lshl_b32 s5, s5, 2
  s_add_u32 s5, s5, s3
  s_lshl_b32 s57, s5, 7
  s_mov_b32 s58, s57
  v_mov_b32 v160, 159744
  v_mov_b32 v161, 1
  v_lshrrev_b32 v10, 3, v0
  v_mul_u32_u24 v6, 3584, v10
  v_bfe_u32 v10, v0, 4, 1
  v_lshlrev_b32 v10, 2, v10
  v_and_b32 v11, 7, v0
  v_xor_b32 v10, v10, v11
  v_lshl_add_u32 v6, v10, 4, v6
  v_lshrrev_b32 v10, 5, v0
  v_lshlrev_b32 v10, 3, v10
  v_bfe_u32 v11, v0, 2, 2
  v_add_u32 v10, v10, v11
  v_mul_u32_u24 v7, 128, v10
  v_bfe_u32 v10, v0, 4, 1
  v_lshl_add_u32 v7, v10, 5, v7
  v_and_b32 v10, 1, v0
  v_lshl_add_u32 v7, v10, 4, v7
  v_bfe_u32 v10, v0, 1, 1
  v_lshl_add_u32 v7, v10, 3, v7
  v_bfe_u32 v10, v0, 3, 1
  v_lshl_add_u32 v7, v10, 6, v7
  v_add_u32 v7, s6, v7
  v_xor_b32 v8, 64, v7
  v_lshlrev_b32 v9, 4, v0
  v_and_b32 v10, 31, v0
  v_lshlrev_b32 v11, 7, v10
  v_add_u32 v11, s32, v11
  v_add_u32 v11, 73728, v11
  v_bfe_u32 v10, v0, 1, 3
  v_lshrrev_b32 v144, 5, v0
  v_xor_b32 v10, v10, v144
  v_xor_b32 v144, 0, v10
  v_lshl_add_u32 v2, v144, 4, v11
  v_xor_b32 v144, 2, v10
  v_lshl_add_u32 v3, v144, 4, v11
  v_xor_b32 v144, 4, v10
  v_lshl_add_u32 v4, v144, 4, v11
  v_xor_b32 v144, 6, v10
  v_lshl_add_u32 v5, v144, 4, v11
  s_mov_b32 s48, s74
  s_mov_b32 s49, s75
  s_mov_b32 s50, 0xe00
  s_mov_b32 s51, 0x20000
  s_mov_b32 s52, s72
  s_mov_b32 s53, s73
  s_mov_b32 s54, 0x1c0000
  s_mov_b32 s55, 0x20000
  v_lshrrev_b32 v10, 5, v0
  v_lshlrev_b32 v10, 4, v10
  s_add_u32 s60, s57, 1835008
  s_mul_i32 s32, s61, 229376
  s_add_u32 s57, s57, s32
  s_waitcnt lgkmcnt(0)
  s_barrier
  s_cmp_eq_u32 s29, s4
  s_cbranch_scc1 fg_nomlp1
  s_setprio 0
  s_add_u32 m0, s6, 0
  s_add_u32 s56, s57, 28672
  buffer_load_dwordx4 v6, s[52:55], s57 offen lds
  s_add_u32 m0, s6, 1024
  s_add_u32 s57, s57, 57344
  buffer_load_dwordx4 v6, s[52:55], s56 offen lds
  s_cmp_ge_u32 s57, s60
  s_cselect_b32 s56, 1835008, 0
  s_sub_u32 s57, s57, s56
  s_add_u32 m0, s6, 2048
  s_add_u32 s56, s57, 28672
  buffer_load_dwordx4 v6, s[52:55], s57 offen lds
  s_add_u32 m0, s6, 3072
  s_add_u32 s57, s57, 57344
  buffer_load_dwordx4 v6, s[52:55], s56 offen lds
  s_cmp_ge_u32 s57, s60
  s_cselect_b32 s56, 1835008, 0
  s_sub_u32 s57, s57, s56
  s_add_u32 m0, s6, 4096
  s_add_u32 s56, s57, 28672
  buffer_load_dwordx4 v6, s[52:55], s57 offen lds
  s_add_u32 m0, s6, 5120
  s_add_u32 s57, s57, 57344
  buffer_load_dwordx4 v6, s[52:55], s56 offen lds
  s_cmp_ge_u32 s57, s60
  s_cselect_b32 s56, 1835008, 0
  s_sub_u32 s57, s57, s56
  s_add_u32 m0, s6, 6144
  s_add_u32 s56, s57, 28672
  buffer_load_dwordx4 v6, s[52:55], s57 offen lds
  s_add_u32 m0, s6, 7168
  s_add_u32 s57, s57, 57344
  buffer_load_dwordx4 v6, s[52:55], s56 offen lds
  s_cmp_ge_u32 s57, s60
  s_cselect_b32 s56, 1835008, 0
  s_sub_u32 s57, s57, s56
  s_add_u32 m0, s6, 8192
  s_add_u32 s56, s57, 28672
  buffer_load_dwordx4 v6, s[52:55], s57 offen lds
  s_add_u32 m0, s6, 9216
  s_add_u32 s57, s57, 57344
  buffer_load_dwordx4 v6, s[52:55], s56 offen lds
  s_cmp_ge_u32 s57, s60
  s_cselect_b32 s56, 1835008, 0
  s_sub_u32 s57, s57, s56
  s_waitcnt vmcnt(6)
  ds_read_b64_tr_b16 v[12:13], v7 offset:0
  ds_read_b64_tr_b16 v[14:15], v7 offset:512
  ds_read_b64_tr_b16 v[16:17], v8 offset:0
  ds_read_b64_tr_b16 v[18:19], v8 offset:512
  ds_read_b128 v[36:39], v2 offset:0
  ds_read_b128 v[40:43], v2 offset:4096
  ds_read_b64_tr_b16 v[20:21], v7 offset:2048
  ds_read_b64_tr_b16 v[22:23], v7 offset:2560
  ds_read_b64_tr_b16 v[24:25], v8 offset:2048
  ds_read_b64_tr_b16 v[26:27], v8 offset:2560
  ds_read_b128 v[44:47], v3 offset:0
  ds_read_b128 v[48:51], v3 offset:4096
  s_waitcnt vmcnt(4) lgkmcnt(6)
  s_add_u32 m0, s6, 0
  s_add_u32 s56, s57, 28672
  buffer_load_dwordx4 v6, s[52:55], s57 offen lds
  v_mfma_f32_32x32x16_bf16 v[64:79], v[12:15], v[36:39], 0
  ds_read_b64_tr_b16 v[28:29], v7 offset:4096
  ds_read_b64_tr_b16 v[30:31], v7 offset:4608
  ds_read_b64_tr_b16 v[32:33], v8 offset:4096
  v_mfma_f32_32x32x16_bf16 v[96:111], v[16:19], v[36:39], 0
  ds_read_b64_tr_b16 v[34:35], v8 offset:4608
  ds_read_b128 v[52:55], v4 offset:0
  ds_read_b128 v[56:59], v4 offset:4096
  v_mfma_f32_32x32x16_bf16 v[80:95], v[12:15], v[40:43], 0
  s_add_u32 m0, s6, 1024
  s_add_u32 s57, s57, 57344
  buffer_load_dwordx4 v6, s[52:55], s56 offen lds
  s_cmp_ge_u32 s57, s60
  s_cselect_b32 s56, 1835008, 0
  s_sub_u32 s57, s57, s56
  v_mfma_f32_32x32x16_bf16 v[112:127], v[16:19], v[40:43], 0
  s_waitcnt vmcnt(4) lgkmcnt(6)
  s_add_u32 m0, s6, 2048
  s_add_u32 s56, s57, 28672
  buffer_load_dwordx4 v6, s[52:55], s57 offen lds
  v_mfma_f32_32x32x16_bf16 v[64:79], v[20:23], v[44:47], v[64:79]
  ds_read_b64_tr_b16 v[12:13], v7 offset:6144
  ds_read_b64_tr_b16 v[14:15], v7 offset:6656
  ds_read_b64_tr_b16 v[16:17], v8 offset:6144
  v_mfma_f32_32x32x16_bf16 v[96:111], v[24:27], v[44:47], v[96:111]
  ds_read_b64_tr_b16 v[18:19], v8 offset:6656
  ds_read_b128 v[36:39], v5 offset:0
  ds_read_b128 v[40:43], v5 offset:4096
  v_mfma_f32_32x32x16_bf16 v[80:95], v[20:23], v[48:51], v[80:95]
  s_add_u32 m0, s6, 3072
  s_add_u32 s57, s57, 57344
  buffer_load_dwordx4 v6, s[52:55], s56 offen lds
  s_cmp_ge_u32 s57, s60
  s_cselect_b32 s56, 1835008, 0
  s_sub_u32 s57, s57, s56
  v_mfma_f32_32x32x16_bf16 v[112:127], v[24:27], v[48:51], v[112:127]
  s_waitcnt vmcnt(4) lgkmcnt(6)
  s_add_u32 m0, s6, 4096
  s_add_u32 s56, s57, 28672
  buffer_load_dwordx4 v6, s[52:55], s57 offen lds
  v_mfma_f32_32x32x16_bf16 v[64:79], v[28:31], v[52:55], v[64:79]
  ds_read_b64_tr_b16 v[20:21], v7 offset:8192
  ds_read_b64_tr_b16 v[22:23], v7 offset:8704
  ds_read_b64_tr_b16 v[24:25], v8 offset:8192
  v_mfma_f32_32x32x16_bf16 v[96:111], v[32:35], v[52:55], v[96:111]
  ds_read_b64_tr_b16 v[26:27], v8 offset:8704
  ds_read_b128 v[44:47], v2 offset:8192
  ds_read_b128 v[48:51], v2 offset:12288
  v_mfma_f32_32x32x16_bf16 v[80:95], v[28:31], v[56:59], v[80:95]
  s_add_u32 m0, s6, 5120
  s_add_u32 s57, s57, 57344
  buffer_load_dwordx4 v6, s[52:55], s56 offen lds
  s_cmp_ge_u32 s57, s60
  s_cselect_b32 s56, 1835008, 0
  s_sub_u32 s57, s57, s56
  v_mfma_f32_32x32x16_bf16 v[112:127], v[32:35], v[56:59], v[112:127]
  s_waitcnt vmcnt(4) lgkmcnt(6)
  s_add_u32 m0, s6, 6144
  s_add_u32 s56, s57, 28672
  buffer_load_dwordx4 v6, s[52:55], s57 offen lds
  v_mfma_f32_32x32x16_bf16 v[64:79], v[12:15], v[36:39], v[64:79]
  ds_read_b64_tr_b16 v[28:29], v7 offset:0
  ds_read_b64_tr_b16 v[30:31], v7 offset:512
  ds_read_b64_tr_b16 v[32:33], v8 offset:0
  v_mfma_f32_32x32x16_bf16 v[96:111], v[16:19], v[36:39], v[96:111]
  ds_read_b64_tr_b16 v[34:35], v8 offset:512
  ds_read_b128 v[52:55], v3 offset:8192
  ds_read_b128 v[56:59], v3 offset:12288
  v_mfma_f32_32x32x16_bf16 v[80:95], v[12:15], v[40:43], v[80:95]
  s_add_u32 m0, s6, 7168
  s_add_u32 s57, s57, 57344
  buffer_load_dwordx4 v6, s[52:55], s56 offen lds
  s_cmp_ge_u32 s57, s60
  s_cselect_b32 s56, 1835008, 0
  s_sub_u32 s57, s57, s56
  v_mfma_f32_32x32x16_bf16 v[112:127], v[16:19], v[40:43], v[112:127]
  s_waitcnt vmcnt(4) lgkmcnt(6)
  s_add_u32 m0, s6, 8192
  s_add_u32 s56, s57, 28672
  buffer_load_dwordx4 v6, s[52:55], s57 offen lds
  v_mfma_f32_32x32x16_bf16 v[64:79], v[20:23], v[44:47], v[64:79]
  ds_read_b64_tr_b16 v[12:13], v7 offset:2048
  ds_read_b64_tr_b16 v[14:15], v7 offset:2560
  ds_read_b64_tr_b16 v[16:17], v8 offset:2048
  v_mfma_f32_32x32x16_bf16 v[96:111], v[24:27], v[44:47], v[96:111]
  ds_read_b64_tr_b16 v[18:19], v8 offset:2560
  ds_read_b128 v[36:39], v4 offset:8192
  ds_read_b128 v[40:43], v4 offset:12288
  v_mfma_f32_32x32x16_bf16 v[80:95], v[20:23], v[48:51], v[80:95]
  s_add_u32 m0, s6, 9216
  s_add_u32 s57, s57, 57344
  buffer_load_dwordx4 v6, s[52:55], s56 offen lds
  s_cmp_ge_u32 s57, s60
  s_cselect_b32 s56, 1835008, 0
  s_sub_u32 s57, s57, s56
  v_mfma_f32_32x32x16_bf16 v[112:127], v[24:27], v[48:51], v[112:127]
  s_waitcnt vmcnt(4) lgkmcnt(6)
  s_add_u32 m0, s6, 0
  s_add_u32 s56, s57, 28672
  buffer_load_dwordx4 v6, s[52:55], s57 offen lds
  v_mfma_f32_32x32x16_bf16 v[64:79], v[28:31], v[52:55], v[64:79]
  ds_read_b64_tr_b16 v[20:21], v7 offset:4096
  ds_read_b64_tr_b16 v[22:23], v7 offset:4608
  ds_read_b64_tr_b16 v[24:25], v8 offset:4096
  v_mfma_f32_32x32x16_bf16 v[96:111], v[32:35], v[52:55], v[96:111]
  ds_read_b64_tr_b16 v[26:27], v8 offset:4608
  ds_read_b128 v[44:47], v5 offset:8192
  ds_read_b128 v[48:51], v5 offset:12288
  v_mfma_f32_32x32x16_bf16 v[80:95], v[28:31], v[56:59], v[80:95]
  s_add_u32 m0, s6, 1024
  s_add_u32 s57, s57, 57344
  buffer_load_dwordx4 v6, s[52:55], s56 offen lds
  s_cmp_ge_u32 s57, s60
  s_cselect_b32 s56, 1835008, 0
  s_sub_u32 s57, s57, s56
  v_mfma_f32_32x32x16_bf16 v[112:127], v[32:35], v[56:59], v[112:127]
  s_waitcnt vmcnt(4) lgkmcnt(6)
  s_add_u32 m0, s6, 2048
  s_add_u32 s56, s57, 28672
  buffer_load_dwordx4 v6, s[52:55], s57 offen lds
  v_mfma_f32_32x32x16_bf16 v[64:79], v[12:15], v[36:39], v[64:79]
  ds_read_b64_tr_b16 v[28:29], v7 offset:6144
  ds_read_b64_tr_b16 v[30:31], v7 offset:6656
  ds_read_b64_tr_b16 v[32:33], v8 offset:6144
  v_mfma_f32_32x32x16_bf16 v[96:111], v[16:19], v[36:39], v[96:111]
  ds_read_b64_tr_b16 v[34:35], v8 offset:6656
  ds_read_b128 v[52:55], v2 offset:16384
  ds_read_b128 v[56:59], v2 offset:20480
  v_mfma_f32_32x32x16_bf16 v[80:95], v[12:15], v[40:43], v[80:95]
  s_add_u32 m0, s6, 3072
  s_add_u32 s57, s57, 57344
  buffer_load_dwordx4 v6, s[52:55], s56 offen lds
  s_cmp_ge_u32 s57, s60
  s_cselect_b32 s56, 1835008, 0
  s_sub_u32 s57, s57, s56
  v_mfma_f32_32x32x16_bf16 v[112:127], v[16:19], v[40:43], v[112:127]
  s_waitcnt vmcnt(4) lgkmcnt(6)
  s_add_u32 m0, s6, 4096
  s_add_u32 s56, s57, 28672
  buffer_load_dwordx4 v6, s[52:55], s57 offen lds
  v_mfma_f32_32x32x16_bf16 v[64:79], v[20:23], v[44:47], v[64:79]
  ds_read_b64_tr_b16 v[12:13], v7 offset:8192
  ds_read_b64_tr_b16 v[14:15], v7 offset:8704
  ds_read_b64_tr_b16 v[16:17], v8 offset:8192
  v_mfma_f32_32x32x16_bf16 v[96:111], v[24:27], v[44:47], v[96:111]
  ds_read_b64_tr_b16 v[18:19], v8 offset:8704
  ds_read_b128 v[36:39], v3 offset:16384
  ds_read_b128 v[40:43], v3 offset:20480
  v_mfma_f32_32x32x16_bf16 v[80:95], v[20:23], v[48:51], v[80:95]
  s_add_u32 m0, s6, 5120
  s_add_u32 s57, s57, 57344
  buffer_load_dwordx4 v6, s[52:55], s56 offen lds
  s_cmp_ge_u32 s57, s60
  s_cselect_b32 s56, 1835008, 0
  s_sub_u32 s57, s57, s56
  v_mfma_f32_32x32x16_bf16 v[112:127], v[24:27], v[48:51], v[112:127]
  s_waitcnt vmcnt(4) lgkmcnt(6)
  s_add_u32 m0, s6, 6144
  s_add_u32 s56, s57, 28672
  buffer_load_dwordx4 v6, s[52:55], s57 offen lds
  v_mfma_f32_32x32x16_bf16 v[64:79], v[28:31], v[52:55], v[64:79]
  ds_read_b64_tr_b16 v[20:21], v7 offset:0
  ds_read_b64_tr_b16 v[22:23], v7 offset:512
  ds_read_b64_tr_b16 v[24:25], v8 offset:0
  v_mfma_f32_32x32x16_bf16 v[96:111], v[32:35], v[52:55], v[96:111]
  ds_read_b64_tr_b16 v[26:27], v8 offset:512
  ds_read_b128 v[44:47], v4 offset:16384
  ds_read_b128 v[48:51], v4 offset:20480
  v_mfma_f32_32x32x16_bf16 v[80:95], v[28:31], v[56:59], v[80:95]
  s_add_u32 m0, s6, 7168
  s_add_u32 s57, s57, 57344
  buffer_load_dwordx4 v6, s[52:55], s56 offen lds
  s_cmp_ge_u32 s57, s60
  s_cselect_b32 s56, 1835008, 0
  s_sub_u32 s57, s57, s56
  v_mfma_f32_32x32x16_bf16 v[112:127], v[32:35], v[56:59], v[112:127]
  buffer_load_dwordx4 v[128:131], v10, s[48:51], s58 offen offset:0
  buffer_load_dwordx4 v[132:135], v10, s[48:51], s58 offen offset:32
  buffer_load_dwordx4 v[136:139], v10, s[48:51], s58 offen offset:64
  buffer_load_dwordx4 v[140:143], v10, s[48:51], s58 offen offset:96
  s_waitcnt vmcnt(4) lgkmcnt(6)
  s_add_u32 m0, s6, 8192
  s_add_u32 s56, s57, 28672
  buffer_load_dwordx4 v6, s[52:55], s57 offen lds
  v_mfma_f32_32x32x16_bf16 v[64:79], v[12:15], v[36:39], v[64:79]
  ds_read_b64_tr_b16 v[28:29], v7 offset:2048
  ds_read_b64_tr_b16 v[30:31], v7 offset:2560
  ds_read_b64_tr_b16 v[32:33], v8 offset:2048
  v_mfma_f32_32x32x16_bf16 v[96:111], v[16:19], v[36:39], v[96:111]
  ds_read_b64_tr_b16 v[34:35], v8 offset:2560
  ds_read_b128 v[52:55], v5 offset:16384
  ds_read_b128 v[56:59], v5 offset:20480
  v_mfma_f32_32x32x16_bf16 v[80:95], v[12:15], v[40:43], v[80:95]
  s_add_u32 m0, s6, 9216
  s_add_u32 s57, s57, 57344
  buffer_load_dwordx4 v6, s[52:55], s56 offen lds
  s_cmp_ge_u32 s57, s60
  s_cselect_b32 s56, 1835008, 0
  s_sub_u32 s57, s57, s56
  v_mfma_f32_32x32x16_bf16 v[112:127], v[16:19], v[40:43], v[112:127]
  s_waitcnt vmcnt(4) lgkmcnt(6)
  s_add_u32 m0, s6, 0
  s_add_u32 s56, s57, 28672
  buffer_load_dwordx4 v6, s[52:55], s57 offen lds
  v_mfma_f32_32x32x16_bf16 v[64:79], v[20:23], v[44:47], v[64:79]
  ds_read_b64_tr_b16 v[12:13], v7 offset:4096
  ds_read_b64_tr_b16 v[14:15], v7 offset:4608
  ds_read_b64_tr_b16 v[16:17], v8 offset:4096
  v_mfma_f32_32x32x16_bf16 v[96:111], v[24:27], v[44:47], v[96:111]
  ds_read_b64_tr_b16 v[18:19], v8 offset:4608
  ds_read_b128 v[36:39], v2 offset:24576
  ds_read_b128 v[40:43], v2 offset:28672
  v_mfma_f32_32x32x16_bf16 v[80:95], v[20:23], v[48:51], v[80:95]
  s_add_u32 m0, s6, 1024
  s_add_u32 s57, s57, 57344
  buffer_load_dwordx4 v6, s[52:55], s56 offen lds
  s_cmp_ge_u32 s57, s60
  s_cselect_b32 s56, 1835008, 0
  s_sub_u32 s57, s57, s56
  v_mfma_f32_32x32x16_bf16 v[112:127], v[24:27], v[48:51], v[112:127]
  s_waitcnt vmcnt(4) lgkmcnt(6)
  s_add_u32 m0, s6, 2048
  s_add_u32 s56, s57, 28672
  buffer_load_dwordx4 v6, s[52:55], s57 offen lds
  v_mfma_f32_32x32x16_bf16 v[64:79], v[28:31], v[52:55], v[64:79]
  ds_read_b64_tr_b16 v[20:21], v7 offset:6144
  ds_read_b64_tr_b16 v[22:23], v7 offset:6656
  ds_read_b64_tr_b16 v[24:25], v8 offset:6144
  v_mfma_f32_32x32x16_bf16 v[96:111], v[32:35], v[52:55], v[96:111]
  ds_read_b64_tr_b16 v[26:27], v8 offset:6656
  ds_read_b128 v[44:47], v3 offset:24576
  ds_read_b128 v[48:51], v3 offset:28672
  v_mfma_f32_32x32x16_bf16 v[80:95], v[28:31], v[56:59], v[80:95]
  s_add_u32 m0, s6, 3072
  s_add_u32 s57, s57, 57344
  buffer_load_dwordx4 v6, s[52:55], s56 offen lds
  s_cmp_ge_u32 s57, s60
  s_cselect_b32 s56, 1835008, 0
  s_sub_u32 s57, s57, s56
  v_mfma_f32_32x32x16_bf16 v[112:127], v[32:35], v[56:59], v[112:127]
  s_waitcnt vmcnt(4) lgkmcnt(6)
  s_add_u32 m0, s6, 4096
  s_add_u32 s56, s57, 28672
  buffer_load_dwordx4 v6, s[52:55], s57 offen lds
  v_mfma_f32_32x32x16_bf16 v[64:79], v[12:15], v[36:39], v[64:79]
  ds_read_b64_tr_b16 v[28:29], v7 offset:8192
  ds_read_b64_tr_b16 v[30:31], v7 offset:8704
  ds_read_b64_tr_b16 v[32:33], v8 offset:8192
  v_mfma_f32_32x32x16_bf16 v[96:111], v[16:19], v[36:39], v[96:111]
  ds_read_b64_tr_b16 v[34:35], v8 offset:8704
  ds_read_b128 v[52:55], v4 offset:24576
  ds_read_b128 v[56:59], v4 offset:28672
  v_mfma_f32_32x32x16_bf16 v[80:95], v[12:15], v[40:43], v[80:95]
  s_add_u32 m0, s6, 5120
  s_add_u32 s57, s57, 57344
  buffer_load_dwordx4 v6, s[52:55], s56 offen lds
  s_cmp_ge_u32 s57, s60
  s_cselect_b32 s56, 1835008, 0
  s_sub_u32 s57, s57, s56
  v_mfma_f32_32x32x16_bf16 v[112:127], v[16:19], v[40:43], v[112:127]
  s_waitcnt vmcnt(4) lgkmcnt(6)
  s_add_u32 m0, s6, 6144
  s_add_u32 s56, s57, 28672
  buffer_load_dwordx4 v6, s[52:55], s57 offen lds
  v_mfma_f32_32x32x16_bf16 v[64:79], v[20:23], v[44:47], v[64:79]
  ds_read_b64_tr_b16 v[12:13], v7 offset:0
  ds_read_b64_tr_b16 v[14:15], v7 offset:512
  ds_read_b64_tr_b16 v[16:17], v8 offset:0
  v_mfma_f32_32x32x16_bf16 v[96:111], v[24:27], v[44:47], v[96:111]
  ds_read_b64_tr_b16 v[18:19], v8 offset:512
  ds_read_b128 v[36:39], v5 offset:24576
  ds_read_b128 v[40:43], v5 offset:28672
  v_mfma_f32_32x32x16_bf16 v[80:95], v[20:23], v[48:51], v[80:95]
  s_add_u32 m0, s6, 7168
  s_add_u32 s57, s57, 57344
  buffer_load_dwordx4 v6, s[52:55], s56 offen lds
  s_cmp_ge_u32 s57, s60
  s_cselect_b32 s56, 1835008, 0
  s_sub_u32 s57, s57, s56
  v_mfma_f32_32x32x16_bf16 v[112:127], v[24:27], v[48:51], v[112:127]
  s_waitcnt vmcnt(4) lgkmcnt(6)
  s_add_u32 m0, s6, 8192
  s_add_u32 s56, s57, 28672
  buffer_load_dwordx4 v6, s[52:55], s57 offen lds
  v_mfma_f32_32x32x16_bf16 v[64:79], v[28:31], v[52:55], v[64:79]
  ds_read_b64_tr_b16 v[20:21], v7 offset:2048
  ds_read_b64_tr_b16 v[22:23], v7 offset:2560
  ds_read_b64_tr_b16 v[24:25], v8 offset:2048
  v_mfma_f32_32x32x16_bf16 v[96:111], v[32:35], v[52:55], v[96:111]
  ds_read_b64_tr_b16 v[26:27], v8 offset:2560
  ds_read_b128 v[44:47], v2 offset:32768
  ds_read_b128 v[48:51], v2 offset:36864
  v_mfma_f32_32x32x16_bf16 v[80:95], v[28:31], v[56:59], v[80:95]
  s_add_u32 m0, s6, 9216
  s_add_u32 s57, s57, 57344
  buffer_load_dwordx4 v6, s[52:55], s56 offen lds
  s_cmp_ge_u32 s57, s60
  s_cselect_b32 s56, 1835008, 0
  s_sub_u32 s57, s57, s56
  v_mfma_f32_32x32x16_bf16 v[112:127], v[32:35], v[56:59], v[112:127]
  s_waitcnt vmcnt(4) lgkmcnt(6)
  s_add_u32 m0, s6, 0
  s_add_u32 s56, s57, 28672
  buffer_load_dwordx4 v6, s[52:55], s57 offen lds
  v_mfma_f32_32x32x16_bf16 v[64:79], v[12:15], v[36:39], v[64:79]
  ds_read_b64_tr_b16 v[28:29], v7 offset:4096
  ds_read_b64_tr_b16 v[30:31], v7 offset:4608
  ds_read_b64_tr_b16 v[32:33], v8 offset:4096
  v_mfma_f32_32x32x16_bf16 v[96:111], v[16:19], v[36:39], v[96:111]
  ds_read_b64_tr_b16 v[34:35], v8 offset:4608
  ds_read_b128 v[52:55], v3 offset:32768
  ds_read_b128 v[56:59], v3 offset:36864
  v_mfma_f32_32x32x16_bf16 v[80:95], v[12:15], v[40:43], v[80:95]
  s_add_u32 m0, s6, 1024
  s_add_u32 s57, s57, 57344
  buffer_load_dwordx4 v6, s[52:55], s56 offen lds
  s_cmp_ge_u32 s57, s60
  s_cselect_b32 s56, 1835008, 0
  s_sub_u32 s57, s57, s56
  v_mfma_f32_32x32x16_bf16 v[112:127], v[16:19], v[40:43], v[112:127]
  s_waitcnt vmcnt(4) lgkmcnt(6)
  s_add_u32 m0, s6, 2048
  s_add_u32 s56, s57, 28672
  buffer_load_dwordx4 v6, s[52:55], s57 offen lds
  v_mfma_f32_32x32x16_bf16 v[64:79], v[20:23], v[44:47], v[64:79]
  ds_read_b64_tr_b16 v[12:13], v7 offset:6144
  ds_read_b64_tr_b16 v[14:15], v7 offset:6656
  ds_read_b64_tr_b16 v[16:17], v8 offset:6144
  v_mfma_f32_32x32x16_bf16 v[96:111], v[24:27], v[44:47], v[96:111]
  ds_read_b64_tr_b16 v[18:19], v8 offset:6656
  ds_read_b128 v[36:39], v4 offset:32768
  ds_read_b128 v[40:43], v4 offset:36864
  v_mfma_f32_32x32x16_bf16 v[80:95], v[20:23], v[48:51], v[80:95]
  s_add_u32 m0, s6, 3072
  s_add_u32 s57, s57, 57344
  buffer_load_dwordx4 v6, s[52:55], s56 offen lds
  s_cmp_ge_u32 s57, s60
  s_cselect_b32 s56, 1835008, 0
  s_sub_u32 s57, s57, s56
  v_mfma_f32_32x32x16_bf16 v[112:127], v[24:27], v[48:51], v[112:127]
  s_waitcnt vmcnt(4) lgkmcnt(6)
  s_add_u32 m0, s6, 4096
  s_add_u32 s56, s57, 28672
  buffer_load_dwordx4 v6, s[52:55], s57 offen lds
  v_mfma_f32_32x32x16_bf16 v[64:79], v[28:31], v[52:55], v[64:79]
  ds_read_b64_tr_b16 v[20:21], v7 offset:8192
  ds_read_b64_tr_b16 v[22:23], v7 offset:8704
  ds_read_b64_tr_b16 v[24:25], v8 offset:8192
  v_mfma_f32_32x32x16_bf16 v[96:111], v[32:35], v[52:55], v[96:111]
  ds_read_b64_tr_b16 v[26:27], v8 offset:8704
  ds_read_b128 v[44:47], v5 offset:32768
  ds_read_b128 v[48:51], v5 offset:36864
  v_mfma_f32_32x32x16_bf16 v[80:95], v[28:31], v[56:59], v[80:95]
  s_add_u32 m0, s6, 5120
  s_add_u32 s57, s57, 57344
  buffer_load_dwordx4 v6, s[52:55], s56 offen lds
  s_cmp_ge_u32 s57, s60
  s_cselect_b32 s56, 1835008, 0
  s_sub_u32 s57, s57, s56
  v_mfma_f32_32x32x16_bf16 v[112:127], v[32:35], v[56:59], v[112:127]
  s_waitcnt vmcnt(4) lgkmcnt(6)
  s_add_u32 m0, s6, 6144
  s_add_u32 s56, s57, 28672
  buffer_load_dwordx4 v6, s[52:55], s57 offen lds
  v_mfma_f32_32x32x16_bf16 v[64:79], v[12:15], v[36:39], v[64:79]
  ds_read_b64_tr_b16 v[28:29], v7 offset:0
  ds_read_b64_tr_b16 v[30:31], v7 offset:512
  ds_read_b64_tr_b16 v[32:33], v8 offset:0
  v_mfma_f32_32x32x16_bf16 v[96:111], v[16:19], v[36:39], v[96:111]
  ds_read_b64_tr_b16 v[34:35], v8 offset:512
  ds_read_b128 v[52:55], v2 offset:40960
  ds_read_b128 v[56:59], v2 offset:45056
  v_mfma_f32_32x32x16_bf16 v[80:95], v[12:15], v[40:43], v[80:95]
  s_add_u32 m0, s6, 7168
  s_add_u32 s57, s57, 57344
  buffer_load_dwordx4 v6, s[52:55], s56 offen lds
  s_cmp_ge_u32 s57, s60
  s_cselect_b32 s56, 1835008, 0
  s_sub_u32 s57, s57, s56
  v_mfma_f32_32x32x16_bf16 v[112:127], v[16:19], v[40:43], v[112:127]
  s_waitcnt vmcnt(4) lgkmcnt(6)
  s_add_u32 m0, s6, 8192
  s_add_u32 s56, s57, 28672
  buffer_load_dwordx4 v6, s[52:55], s57 offen lds
  v_mfma_f32_32x32x16_bf16 v[64:79], v[20:23], v[44:47], v[64:79]
  ds_read_b64_tr_b16 v[12:13], v7 offset:2048
  ds_read_b64_tr_b16 v[14:15], v7 offset:2560
  ds_read_b64_tr_b16 v[16:17], v8 offset:2048
  v_mfma_f32_32x32x16_bf16 v[96:111], v[24:27], v[44:47], v[96:111]
  ds_read_b64_tr_b16 v[18:19], v8 offset:2560
  ds_read_b128 v[36:39], v3 offset:40960
  ds_read_b128 v[40:43], v3 offset:45056
  v_mfma_f32_32x32x16_bf16 v[80:95], v[20:23], v[48:51], v[80:95]
  s_add_u32 m0, s6, 9216
  s_add_u32 s57, s57, 57344
  buffer_load_dwordx4 v6, s[52:55], s56 offen lds
  s_cmp_ge_u32 s57, s60
  s_cselect_b32 s56, 1835008, 0
  s_sub_u32 s57, s57, s56
  v_mfma_f32_32x32x16_bf16 v[112:127], v[24:27], v[48:51], v[112:127]
  s_waitcnt vmcnt(4) lgkmcnt(6)
  s_add_u32 m0, s6, 0
  s_add_u32 s56, s57, 28672
  buffer_load_dwordx4 v6, s[52:55], s57 offen lds
  v_mfma_f32_32x32x16_bf16 v[64:79], v[28:31], v[52:55], v[64:79]
  ds_read_b64_tr_b16 v[20:21], v7 offset:4096
  ds_read_b64_tr_b16 v[22:23], v7 offset:4608
  ds_read_b64_tr_b16 v[24:25], v8 offset:4096
  v_mfma_f32_32x32x16_bf16 v[96:111], v[32:35], v[52:55], v[96:111]
  ds_read_b64_tr_b16 v[26:27], v8 offset:4608
  ds_read_b128 v[44:47], v4 offset:40960
  ds_read_b128 v[48:51], v4 offset:45056
  v_mfma_f32_32x32x16_bf16 v[80:95], v[28:31], v[56:59], v[80:95]
  s_add_u32 m0, s6, 1024
  s_add_u32 s57, s57, 57344
  buffer_load_dwordx4 v6, s[52:55], s56 offen lds
  s_cmp_ge_u32 s57, s60
  s_cselect_b32 s56, 1835008, 0
  s_sub_u32 s57, s57, s56
  v_mfma_f32_32x32x16_bf16 v[112:127], v[32:35], v[56:59], v[112:127]
  s_waitcnt vmcnt(4) lgkmcnt(6)
  s_add_u32 m0, s6, 2048
  s_add_u32 s56, s57, 28672
  buffer_load_dwordx4 v6, s[52:55], s57 offen lds
  v_mfma_f32_32x32x16_bf16 v[64:79], v[12:15], v[36:39], v[64:79]
  ds_read_b64_tr_b16 v[28:29], v7 offset:6144
  ds_read_b64_tr_b16 v[30:31], v7 offset:6656
  ds_read_b64_tr_b16 v[32:33], v8 offset:6144
  v_mfma_f32_32x32x16_bf16 v[96:111], v[16:19], v[36:39], v[96:111]
  ds_read_b64_tr_b16 v[34:35], v8 offset:6656
  ds_read_b128 v[52:55], v5 offset:40960
  ds_read_b128 v[56:59], v5 offset:45056
  v_mfma_f32_32x32x16_bf16 v[80:95], v[12:15], v[40:43], v[80:95]
  s_add_u32 m0, s6, 3072
  s_add_u32 s57, s57, 57344
  buffer_load_dwordx4 v6, s[52:55], s56 offen lds
  s_cmp_ge_u32 s57, s60
  s_cselect_b32 s56, 1835008, 0
  s_sub_u32 s57, s57, s56
  v_mfma_f32_32x32x16_bf16 v[112:127], v[16:19], v[40:43], v[112:127]
  s_waitcnt vmcnt(4) lgkmcnt(6)
  s_add_u32 m0, s6, 4096
  s_add_u32 s56, s57, 28672
  buffer_load_dwordx4 v6, s[52:55], s57 offen lds
  v_mfma_f32_32x32x16_bf16 v[64:79], v[20:23], v[44:47], v[64:79]
  ds_read_b64_tr_b16 v[12:13], v7 offset:8192
  ds_read_b64_tr_b16 v[14:15], v7 offset:8704
  ds_read_b64_tr_b16 v[16:17], v8 offset:8192
  v_mfma_f32_32x32x16_bf16 v[96:111], v[24:27], v[44:47], v[96:111]
  ds_read_b64_tr_b16 v[18:19], v8 offset:8704
  ds_read_b128 v[36:39], v2 offset:49152
  ds_read_b128 v[40:43], v2 offset:53248
  v_mfma_f32_32x32x16_bf16 v[80:95], v[20:23], v[48:51], v[80:95]
  s_add_u32 m0, s6, 5120
  s_add_u32 s57, s57, 57344
  buffer_load_dwordx4 v6, s[52:55], s56 offen lds
  s_cmp_ge_u32 s57, s60
  s_cselect_b32 s56, 1835008, 0
  s_sub_u32 s57, s57, s56
  v_mfma_f32_32x32x16_bf16 v[112:127], v[24:27], v[48:51], v[112:127]
  s_waitcnt vmcnt(4) lgkmcnt(6)
  s_add_u32 m0, s6, 6144
  s_add_u32 s56, s57, 28672
  buffer_load_dwordx4 v6, s[52:55], s57 offen lds
  v_mfma_f32_32x32x16_bf16 v[64:79], v[28:31], v[52:55], v[64:79]
  ds_read_b64_tr_b16 v[20:21], v7 offset:0
  ds_read_b64_tr_b16 v[22:23], v7 offset:512
  ds_read_b64_tr_b16 v[24:25], v8 offset:0
  v_mfma_f32_32x32x16_bf16 v[96:111], v[32:35], v[52:55], v[96:111]
  ds_read_b64_tr_b16 v[26:27], v8 offset:512
  ds_read_b128 v[44:47], v3 offset:49152
  ds_read_b128 v[48:51], v3 offset:53248
  v_mfma_f32_32x32x16_bf16 v[80:95], v[28:31], v[56:59], v[80:95]
  s_add_u32 m0, s6, 7168
  s_add_u32 s57, s57, 57344
  buffer_load_dwordx4 v6, s[52:55], s56 offen lds
  s_cmp_ge_u32 s57, s60
  s_cselect_b32 s56, 1835008, 0
  s_sub_u32 s57, s57, s56
  v_mfma_f32_32x32x16_bf16 v[112:127], v[32:35], v[56:59], v[112:127]
  s_waitcnt vmcnt(4) lgkmcnt(6)
  s_add_u32 m0, s6, 8192
  s_add_u32 s56, s57, 28672
  buffer_load_dwordx4 v6, s[52:55], s57 offen lds
  v_mfma_f32_32x32x16_bf16 v[64:79], v[12:15], v[36:39], v[64:79]
  ds_read_b64_tr_b16 v[28:29], v7 offset:2048
  ds_read_b64_tr_b16 v[30:31], v7 offset:2560
  ds_read_b64_tr_b16 v[32:33], v8 offset:2048
  v_mfma_f32_32x32x16_bf16 v[96:111], v[16:19], v[36:39], v[96:111]
  ds_read_b64_tr_b16 v[34:35], v8 offset:2560
  ds_read_b128 v[52:55], v4 offset:49152
  ds_read_b128 v[56:59], v4 offset:53248
  v_mfma_f32_32x32x16_bf16 v[80:95], v[12:15], v[40:43], v[80:95]
  s_add_u32 m0, s6, 9216
  s_add_u32 s57, s57, 57344
  buffer_load_dwordx4 v6, s[52:55], s56 offen lds
  s_cmp_ge_u32 s57, s60
  s_cselect_b32 s56, 1835008, 0
  s_sub_u32 s57, s57, s56
  v_mfma_f32_32x32x16_bf16 v[112:127], v[16:19], v[40:43], v[112:127]
  s_waitcnt vmcnt(4) lgkmcnt(6)
  s_add_u32 m0, s6, 0
  s_add_u32 s56, s57, 28672
  buffer_load_dwordx4 v6, s[52:55], s57 offen lds
  v_mfma_f32_32x32x16_bf16 v[64:79], v[20:23], v[44:47], v[64:79]
  ds_read_b64_tr_b16 v[12:13], v7 offset:4096
  ds_read_b64_tr_b16 v[14:15], v7 offset:4608
  ds_read_b64_tr_b16 v[16:17], v8 offset:4096
  v_mfma_f32_32x32x16_bf16 v[96:111], v[24:27], v[44:47], v[96:111]
  ds_read_b64_tr_b16 v[18:19], v8 offset:4608
  ds_read_b128 v[36:39], v5 offset:49152
  ds_read_b128 v[40:43], v5 offset:53248
  v_mfma_f32_32x32x16_bf16 v[80:95], v[20:23], v[48:51], v[80:95]
  s_add_u32 m0, s6, 1024
  s_add_u32 s57, s57, 57344
  buffer_load_dwordx4 v6, s[52:55], s56 offen lds
  s_cmp_ge_u32 s57, s60
  s_cselect_b32 s56, 1835008, 0
  s_sub_u32 s57, s57, s56
  v_mfma_f32_32x32x16_bf16 v[112:127], v[24:27], v[48:51], v[112:127]
  s_waitcnt vmcnt(4) lgkmcnt(6)
  s_add_u32 m0, s6, 2048
  s_add_u32 s56, s57, 28672
  buffer_load_dwordx4 v6, s[52:55], s57 offen lds
  v_mfma_f32_32x32x16_bf16 v[64:79], v[28:31], v[52:55], v[64:79]
  ds_read_b64_tr_b16 v[20:21], v7 offset:6144
  ds_read_b64_tr_b16 v[22:23], v7 offset:6656
  ds_read_b64_tr_b16 v[24:25], v8 offset:6144
  v_mfma_f32_32x32x16_bf16 v[96:111], v[32:35], v[52:55], v[96:111]
  ds_read_b64_tr_b16 v[26:27], v8 offset:6656
  ds_read_b128 v[44:47], v2 offset:57344
  ds_read_b128 v[48:51], v2 offset:61440
  v_mfma_f32_32x32x16_bf16 v[80:95], v[28:31], v[56:59], v[80:95]
  s_add_u32 m0, s6, 3072
  s_add_u32 s57, s57, 57344
  buffer_load_dwordx4 v6, s[52:55], s56 offen lds
  s_cmp_ge_u32 s57, s60
  s_cselect_b32 s56, 1835008, 0
  s_sub_u32 s57, s57, s56
  v_mfma_f32_32x32x16_bf16 v[112:127], v[32:35], v[56:59], v[112:127]
  s_waitcnt vmcnt(4) lgkmcnt(6)
  v_mfma_f32_32x32x16_bf16 v[64:79], v[12:15], v[36:39], v[64:79]
  ds_read_b64_tr_b16 v[28:29], v7 offset:8192
  ds_read_b64_tr_b16 v[30:31], v7 offset:8704
  ds_read_b64_tr_b16 v[32:33], v8 offset:8192
  v_mfma_f32_32x32x16_bf16 v[96:111], v[16:19], v[36:39], v[96:111]
  ds_read_b64_tr_b16 v[34:35], v8 offset:8704
  ds_read_b128 v[52:55], v3 offset:57344
  ds_read_b128 v[56:59], v3 offset:61440
  v_mfma_f32_32x32x16_bf16 v[80:95], v[12:15], v[40:43], v[80:95]
  v_mfma_f32_32x32x16_bf16 v[112:127], v[16:19], v[40:43], v[112:127]
  s_waitcnt vmcnt(2) lgkmcnt(6)
  v_mfma_f32_32x32x16_bf16 v[64:79], v[20:23], v[44:47], v[64:79]
  ds_read_b64_tr_b16 v[12:13], v7 offset:0
  ds_read_b64_tr_b16 v[14:15], v7 offset:512
  ds_read_b64_tr_b16 v[16:17], v8 offset:0
  v_mfma_f32_32x32x16_bf16 v[96:111], v[24:27], v[44:47], v[96:111]
  ds_read_b64_tr_b16 v[18:19], v8 offset:512
  ds_read_b128 v[36:39], v4 offset:57344
  ds_read_b128 v[40:43], v4 offset:61440
  v_mfma_f32_32x32x16_bf16 v[80:95], v[20:23], v[48:51], v[80:95]
  v_mfma_f32_32x32x16_bf16 v[112:127], v[24:27], v[48:51], v[112:127]
  s_waitcnt vmcnt(0) lgkmcnt(6)
  v_mfma_f32_32x32x16_bf16 v[64:79], v[28:31], v[52:55], v[64:79]
  ds_read_b64_tr_b16 v[20:21], v7 offset:2048
  ds_read_b64_tr_b16 v[22:23], v7 offset:2560
  ds_read_b64_tr_b16 v[24:25], v8 offset:2048
  v_mfma_f32_32x32x16_bf16 v[96:111], v[32:35], v[52:55], v[96:111]
  ds_read_b64_tr_b16 v[26:27], v8 offset:2560
  ds_read_b128 v[44:47], v5 offset:57344
  ds_read_b128 v[48:51], v5 offset:61440
  v_mfma_f32_32x32x16_bf16 v[80:95], v[28:31], v[56:59], v[80:95]
  v_mfma_f32_32x32x16_bf16 v[112:127], v[32:35], v[56:59], v[112:127]
  s_waitcnt lgkmcnt(6)
  v_mfma_f32_32x32x16_bf16 v[64:79], v[12:15], v[36:39], v[64:79]
  v_mfma_f32_32x32x16_bf16 v[96:111], v[16:19], v[36:39], v[96:111]
  v_mfma_f32_32x32x16_bf16 v[80:95], v[12:15], v[40:43], v[80:95]
  v_mfma_f32_32x32x16_bf16 v[112:127], v[16:19], v[40:43], v[112:127]
  s_waitcnt lgkmcnt(0)
  v_mfma_f32_32x32x16_bf16 v[64:79], v[20:23], v[44:47], v[64:79]
  v_mfma_f32_32x32x16_bf16 v[96:111], v[24:27], v[44:47], v[96:111]
  v_mfma_f32_32x32x16_bf16 v[80:95], v[20:23], v[48:51], v[80:95]
  v_mfma_f32_32x32x16_bf16 v[112:127], v[24:27], v[48:51], v[112:127]
  s_mov_b64 exec, 1
  ds_add_u32 v160, v161 offset:40
  s_mov_b64 exec, -1
  s_setprio 2
  v_and_b32 v10, 31, v0
  v_lshlrev_b32 v10, 4, v10
  v_add_u32 v10, 161024, v10
  ds_read_b128 v[12:15], v10
  ds_read_b128 v[16:19], v10 offset:512
  v_mov_b32 v11, 0x3727c5ac
  s_mov_b32 s34, 0x3b000000
  s_waitcnt lgkmcnt(0)
  v_pk_add_f32 v[12:13], v[12:13], v[14:15]
  v_pk_add_f32 v[16:17], v[16:17], v[18:19]
  v_add_f32 v12, v12, v13
  v_add_f32 v16, v16, v17
  v_fma_f32 v12, v12, s34, v11
  v_fma_f32 v16, v16, s34, v11
  v_rsq_f32 v60, v12
  v_rsq_f32 v62, v16
  s_nop 0
  v_mov_b32 v61, v60
  v_mov_b32 v63, v62
  s_mov_b32 s16, s76
  s_mov_b32 s17, s77
  s_mov_b32 s18, 0x1c0000
  s_mov_b32 s19, 0x20000
  s_and_b32 s30, s2, 7
  s_lshr_b32 s31, s2, 3
  s_lshr_b32 s32, s30, 2
  v_lshlrev_b32 v12, 16, v128
  v_and_b32 v13, 0xffff0000, v128
  v_lshlrev_b32 v14, 16, v129
  v_and_b32 v15, 0xffff0000, v129
  v_lshlrev_b32 v16, 16, v130
  v_and_b32 v17, 0xffff0000, v130
  v_lshlrev_b32 v18, 16, v131
  v_and_b32 v19, 0xffff0000, v131
  v_lshlrev_b32 v20, 16, v132
  v_and_b32 v21, 0xffff0000, v132
  v_lshlrev_b32 v22, 16, v133
  v_and_b32 v23, 0xffff0000, v133
  v_lshlrev_b32 v24, 16, v134
  v_and_b32 v25, 0xffff0000, v134
  v_lshlrev_b32 v26, 16, v135
  v_and_b32 v27, 0xffff0000, v135
  v_lshlrev_b32 v28, 16, v136
  v_and_b32 v29, 0xffff0000, v136
  v_lshlrev_b32 v30, 16, v137
  v_and_b32 v31, 0xffff0000, v137
  v_lshlrev_b32 v32, 16, v138
  v_and_b32 v33, 0xffff0000, v138
  v_lshlrev_b32 v34, 16, v139
  v_and_b32 v35, 0xffff0000, v139
  v_lshlrev_b32 v36, 16, v140
  v_and_b32 v37, 0xffff0000, v140
  v_lshlrev_b32 v38, 16, v141
  v_and_b32 v39, 0xffff0000, v141
  v_lshlrev_b32 v40, 16, v142
  v_and_b32 v41, 0xffff0000, v142
  v_lshlrev_b32 v42, 16, v143
  v_and_b32 v43, 0xffff0000, v143
  v_mov_b32 v144, 0xc0135761
  v_mov_b32 v145, 0xc0135761
  v_mov_b32 v146, 0xbdd2d3e8
  v_mov_b32 v147, 0xbdd2d3e8
  v_mov_b32 v148, 0x3f800000
  v_mov_b32 v149, 0x3f800000
  s_mul_i32 s57, s28, 229376
  s_lshl_b32 s58, s5, 12
  s_add_u32 s57, s57, s58
  s_add_u32 s57, s57, 10485760
  s_add_u32 s58, s57, 114688
  s_lshl_b32 s59, s28, 8
  s_add_u32 s59, s59, 17891328
  v_pk_fma_f32 v[64:65], v[64:65], v[60:61], v[12:13]
  v_pk_fma_f32 v[66:67], v[66:67], v[60:61], v[14:15]
  v_pk_fma_f32 v[68:69], v[68:69], v[60:61], v[16:17]
  v_pk_fma_f32 v[70:71], v[70:71], v[60:61], v[18:19]
  v_pk_fma_f32 v[72:73], v[72:73], v[60:61], v[20:21]
  v_pk_fma_f32 v[74:75], v[74:75], v[60:61], v[22:23]
  v_pk_fma_f32 v[76:77], v[76:77], v[60:61], v[24:25]
  v_pk_fma_f32 v[78:79], v[78:79], v[60:61], v[26:27]
  v_pk_mul_f32 v[150:151], v[64:65], v[64:65]
  v_pk_mul_f32 v[152:153], v[66:67], v[66:67]
  v_pk_fma_f32 v[150:151], v[150:151], v[146:147], v[144:145]
  v_pk_fma_f32 v[152:153], v[152:153], v[146:147], v[144:145]
  v_pk_mul_f32 v[150:151], v[150:151], v[64:65]
  v_pk_mul_f32 v[152:153], v[152:153], v[66:67]
  v_exp_f32 v154, v150
  v_exp_f32 v155, v151
  v_exp_f32 v156, v152
  v_exp_f32 v157, v153
  v_pk_add_f32 v[154:155], v[154:155], v[148:149]
  v_pk_add_f32 v[156:157], v[156:157], v[148:149]
  v_rcp_f32 v154, v154
  v_rcp_f32 v155, v155
  v_rcp_f32 v156, v156
  v_rcp_f32 v157, v157
  v_pk_mul_f32 v[154:155], v[154:155], v[64:65]
  v_pk_mul_f32 v[156:157], v[156:157], v[66:67]
  v_cvt_pk_bf16_f32 v44, v154, v155
  v_cvt_pk_bf16_f32 v45, v156, v157
  v_pk_mul_f32 v[150:151], v[68:69], v[68:69]
  v_pk_mul_f32 v[152:153], v[70:71], v[70:71]
  v_pk_fma_f32 v[150:151], v[150:151], v[146:147], v[144:145]
  v_pk_fma_f32 v[152:153], v[152:153], v[146:147], v[144:145]
  v_pk_mul_f32 v[150:151], v[150:151], v[68:69]
  v_pk_mul_f32 v[152:153], v[152:153], v[70:71]
  v_exp_f32 v154, v150
  v_exp_f32 v155, v151
  v_exp_f32 v156, v152
  v_exp_f32 v157, v153
  v_pk_add_f32 v[154:155], v[154:155], v[148:149]
  v_pk_add_f32 v[156:157], v[156:157], v[148:149]
  v_rcp_f32 v154, v154
  v_rcp_f32 v155, v155
  v_rcp_f32 v156, v156
  v_rcp_f32 v157, v157
  v_pk_mul_f32 v[154:155], v[154:155], v[68:69]
  v_pk_mul_f32 v[156:157], v[156:157], v[70:71]
  v_cvt_pk_bf16_f32 v46, v154, v155
  v_cvt_pk_bf16_f32 v47, v156, v157
  v_pk_mul_f32 v[150:151], v[72:73], v[72:73]
  v_pk_mul_f32 v[152:153], v[74:75], v[74:75]
  v_pk_fma_f32 v[150:151], v[150:151], v[146:147], v[144:145]
  v_pk_fma_f32 v[152:153], v[152:153], v[146:147], v[144:145]
  v_pk_mul_f32 v[150:151], v[150:151], v[72:73]
  v_pk_mul_f32 v[152:153], v[152:153], v[74:75]
  v_exp_f32 v154, v150
  v_exp_f32 v155, v151
  v_exp_f32 v156, v152
  v_exp_f32 v157, v153
  v_pk_add_f32 v[154:155], v[154:155], v[148:149]
  v_pk_add_f32 v[156:157], v[156:157], v[148:149]
  v_rcp_f32 v154, v154
  v_rcp_f32 v155, v155
  v_rcp_f32 v156, v156
  v_rcp_f32 v157, v157
  v_pk_mul_f32 v[154:155], v[154:155], v[72:73]
  v_pk_mul_f32 v[156:157], v[156:157], v[74:75]
  v_cvt_pk_bf16_f32 v48, v154, v155
  v_cvt_pk_bf16_f32 v49, v156, v157
  v_pk_mul_f32 v[150:151], v[76:77], v[76:77]
  v_pk_mul_f32 v[152:153], v[78:79], v[78:79]
  v_pk_fma_f32 v[150:151], v[150:151], v[146:147], v[144:145]
  v_pk_fma_f32 v[152:153], v[152:153], v[146:147], v[144:145]
  v_pk_mul_f32 v[150:151], v[150:151], v[76:77]
  v_pk_mul_f32 v[152:153], v[152:153], v[78:79]
  v_exp_f32 v154, v150
  v_exp_f32 v155, v151
  v_exp_f32 v156, v152
  v_exp_f32 v157, v153
  v_pk_add_f32 v[154:155], v[154:155], v[148:149]
  v_pk_add_f32 v[156:157], v[156:157], v[148:149]
  v_rcp_f32 v154, v154
  v_rcp_f32 v155, v155
  v_rcp_f32 v156, v156
  v_rcp_f32 v157, v157
  v_pk_mul_f32 v[154:155], v[154:155], v[76:77]
  v_pk_mul_f32 v[156:157], v[156:157], v[78:79]
  v_cvt_pk_bf16_f32 v50, v154, v155
  v_cvt_pk_bf16_f32 v51, v156, v157
  buffer_store_dwordx4 v[44:47], v9, s[12:15], s57 offen offset:0 sc1
  buffer_store_dwordx4 v[48:51], v9, s[12:15], s57 offen offset:1024 sc1
  v_pk_fma_f32 v[80:81], v[80:81], v[62:63], v[12:13]
  v_pk_fma_f32 v[82:83], v[82:83], v[62:63], v[14:15]
  v_pk_fma_f32 v[84:85], v[84:85], v[62:63], v[16:17]
  v_pk_fma_f32 v[86:87], v[86:87], v[62:63], v[18:19]
  v_pk_fma_f32 v[88:89], v[88:89], v[62:63], v[20:21]
  v_pk_fma_f32 v[90:91], v[90:91], v[62:63], v[22:23]
  v_pk_fma_f32 v[92:93], v[92:93], v[62:63], v[24:25]
  v_pk_fma_f32 v[94:95], v[94:95], v[62:63], v[26:27]
  v_pk_mul_f32 v[150:151], v[80:81], v[80:81]
  v_pk_mul_f32 v[152:153], v[82:83], v[82:83]
  v_pk_fma_f32 v[150:151], v[150:151], v[146:147], v[144:145]
  v_pk_fma_f32 v[152:153], v[152:153], v[146:147], v[144:145]
  v_pk_mul_f32 v[150:151], v[150:151], v[80:81]
  v_pk_mul_f32 v[152:153], v[152:153], v[82:83]
  v_exp_f32 v154, v150
  v_exp_f32 v155, v151
  v_exp_f32 v156, v152
  v_exp_f32 v157, v153
  v_pk_add_f32 v[154:155], v[154:155], v[148:149]
  v_pk_add_f32 v[156:157], v[156:157], v[148:149]
  v_rcp_f32 v154, v154
  v_rcp_f32 v155, v155
  v_rcp_f32 v156, v156
  v_rcp_f32 v157, v157
  v_pk_mul_f32 v[154:155], v[154:155], v[80:81]
  v_pk_mul_f32 v[156:157], v[156:157], v[82:83]
  v_cvt_pk_bf16_f32 v52, v154, v155
  v_cvt_pk_bf16_f32 v53, v156, v157
  v_pk_mul_f32 v[150:151], v[84:85], v[84:85]
  v_pk_mul_f32 v[152:153], v[86:87], v[86:87]
  v_pk_fma_f32 v[150:151], v[150:151], v[146:147], v[144:145]
  v_pk_fma_f32 v[152:153], v[152:153], v[146:147], v[144:145]
  v_pk_mul_f32 v[150:151], v[150:151], v[84:85]
  v_pk_mul_f32 v[152:153], v[152:153], v[86:87]
  v_exp_f32 v154, v150
  v_exp_f32 v155, v151
  v_exp_f32 v156, v152
  v_exp_f32 v157, v153
  v_pk_add_f32 v[154:155], v[154:155], v[148:149]
  v_pk_add_f32 v[156:157], v[156:157], v[148:149]
  v_rcp_f32 v154, v154
  v_rcp_f32 v155, v155
  v_rcp_f32 v156, v156
  v_rcp_f32 v157, v157
  v_pk_mul_f32 v[154:155], v[154:155], v[84:85]
  v_pk_mul_f32 v[156:157], v[156:157], v[86:87]
  v_cvt_pk_bf16_f32 v54, v154, v155
  v_cvt_pk_bf16_f32 v55, v156, v157
  v_pk_mul_f32 v[150:151], v[88:89], v[88:89]
  v_pk_mul_f32 v[152:153], v[90:91], v[90:91]
  v_pk_fma_f32 v[150:151], v[150:151], v[146:147], v[144:145]
  v_pk_fma_f32 v[152:153], v[152:153], v[146:147], v[144:145]
  v_pk_mul_f32 v[150:151], v[150:151], v[88:89]
  v_pk_mul_f32 v[152:153], v[152:153], v[90:91]
  v_exp_f32 v154, v150
  v_exp_f32 v155, v151
  v_exp_f32 v156, v152
  v_exp_f32 v157, v153
  v_pk_add_f32 v[154:155], v[154:155], v[148:149]
  v_pk_add_f32 v[156:157], v[156:157], v[148:149]
  v_rcp_f32 v154, v154
  v_rcp_f32 v155, v155
  v_rcp_f32 v156, v156
  v_rcp_f32 v157, v157
  v_pk_mul_f32 v[154:155], v[154:155], v[88:89]
  v_pk_mul_f32 v[156:157], v[156:157], v[90:91]
  v_cvt_pk_bf16_f32 v56, v154, v155
  v_cvt_pk_bf16_f32 v57, v156, v157
  v_pk_mul_f32 v[150:151], v[92:93], v[92:93]
  v_pk_mul_f32 v[152:153], v[94:95], v[94:95]
  v_pk_fma_f32 v[150:151], v[150:151], v[146:147], v[144:145]
  v_pk_fma_f32 v[152:153], v[152:153], v[146:147], v[144:145]
  v_pk_mul_f32 v[150:151], v[150:151], v[92:93]
  v_pk_mul_f32 v[152:153], v[152:153], v[94:95]
  v_exp_f32 v154, v150
  v_exp_f32 v155, v151
  v_exp_f32 v156, v152
  v_exp_f32 v157, v153
  v_pk_add_f32 v[154:155], v[154:155], v[148:149]
  v_pk_add_f32 v[156:157], v[156:157], v[148:149]
  v_rcp_f32 v154, v154
  v_rcp_f32 v155, v155
  v_rcp_f32 v156, v156
  v_rcp_f32 v157, v157
  v_pk_mul_f32 v[154:155], v[154:155], v[92:93]
  v_pk_mul_f32 v[156:157], v[156:157], v[94:95]
  v_cvt_pk_bf16_f32 v58, v154, v155
  v_cvt_pk_bf16_f32 v59, v156, v157
  buffer_store_dwordx4 v[52:55], v9, s[12:15], s58 offen offset:0 sc1
  buffer_store_dwordx4 v[56:59], v9, s[12:15], s58 offen offset:1024 sc1
  v_pk_fma_f32 v[96:97], v[96:97], v[60:61], v[28:29]
  v_pk_fma_f32 v[98:99], v[98:99], v[60:61], v[30:31]
  v_pk_fma_f32 v[100:101], v[100:101], v[60:61], v[32:33]
  v_pk_fma_f32 v[102:103], v[102:103], v[60:61], v[34:35]
  v_pk_fma_f32 v[104:105], v[104:105], v[60:61], v[36:37]
  v_pk_fma_f32 v[106:107], v[106:107], v[60:61], v[38:39]
  v_pk_fma_f32 v[108:109], v[108:109], v[60:61], v[40:41]
  v_pk_fma_f32 v[110:111], v[110:111], v[60:61], v[42:43]
  v_pk_mul_f32 v[150:151], v[96:97], v[96:97]
  v_pk_mul_f32 v[152:153], v[98:99], v[98:99]
  v_pk_fma_f32 v[150:151], v[150:151], v[146:147], v[144:145]
  v_pk_fma_f32 v[152:153], v[152:153], v[146:147], v[144:145]
  v_pk_mul_f32 v[150:151], v[150:151], v[96:97]
  v_pk_mul_f32 v[152:153], v[152:153], v[98:99]
  v_exp_f32 v154, v150
  v_exp_f32 v155, v151
  v_exp_f32 v156, v152
  v_exp_f32 v157, v153
  v_pk_add_f32 v[154:155], v[154:155], v[148:149]
  v_pk_add_f32 v[156:157], v[156:157], v[148:149]
  v_rcp_f32 v154, v154
  v_rcp_f32 v155, v155
  v_rcp_f32 v156, v156
  v_rcp_f32 v157, v157
  v_pk_mul_f32 v[154:155], v[154:155], v[96:97]
  v_pk_mul_f32 v[156:157], v[156:157], v[98:99]
  v_cvt_pk_bf16_f32 v44, v154, v155
  v_cvt_pk_bf16_f32 v45, v156, v157
  v_pk_mul_f32 v[150:151], v[100:101], v[100:101]
  v_pk_mul_f32 v[152:153], v[102:103], v[102:103]
  v_pk_fma_f32 v[150:151], v[150:151], v[146:147], v[144:145]
  v_pk_fma_f32 v[152:153], v[152:153], v[146:147], v[144:145]
  v_pk_mul_f32 v[150:151], v[150:151], v[100:101]
  v_pk_mul_f32 v[152:153], v[152:153], v[102:103]
  v_exp_f32 v154, v150
  v_exp_f32 v155, v151
  v_exp_f32 v156, v152
  v_exp_f32 v157, v153
  v_pk_add_f32 v[154:155], v[154:155], v[148:149]
  v_pk_add_f32 v[156:157], v[156:157], v[148:149]
  v_rcp_f32 v154, v154
  v_rcp_f32 v155, v155
  v_rcp_f32 v156, v156
  v_rcp_f32 v157, v157
  v_pk_mul_f32 v[154:155], v[154:155], v[100:101]
  v_pk_mul_f32 v[156:157], v[156:157], v[102:103]
  v_cvt_pk_bf16_f32 v46, v154, v155
  v_cvt_pk_bf16_f32 v47, v156, v157
  v_pk_mul_f32 v[150:151], v[104:105], v[104:105]
  v_pk_mul_f32 v[152:153], v[106:107], v[106:107]
  v_pk_fma_f32 v[150:151], v[150:151], v[146:147], v[144:145]
  v_pk_fma_f32 v[152:153], v[152:153], v[146:147], v[144:145]
  v_pk_mul_f32 v[150:151], v[150:151], v[104:105]
  v_pk_mul_f32 v[152:153], v[152:153], v[106:107]
  v_exp_f32 v154, v150
  v_exp_f32 v155, v151
  v_exp_f32 v156, v152
  v_exp_f32 v157, v153
  v_pk_add_f32 v[154:155], v[154:155], v[148:149]
  v_pk_add_f32 v[156:157], v[156:157], v[148:149]
  v_rcp_f32 v154, v154
  v_rcp_f32 v155, v155
  v_rcp_f32 v156, v156
  v_rcp_f32 v157, v157
  v_pk_mul_f32 v[154:155], v[154:155], v[104:105]
  v_pk_mul_f32 v[156:157], v[156:157], v[106:107]
  v_cvt_pk_bf16_f32 v48, v154, v155
  v_cvt_pk_bf16_f32 v49, v156, v157
  v_pk_mul_f32 v[150:151], v[108:109], v[108:109]
  v_pk_mul_f32 v[152:153], v[110:111], v[110:111]
  v_pk_fma_f32 v[150:151], v[150:151], v[146:147], v[144:145]
  v_pk_fma_f32 v[152:153], v[152:153], v[146:147], v[144:145]
  v_pk_mul_f32 v[150:151], v[150:151], v[108:109]
  v_pk_mul_f32 v[152:153], v[152:153], v[110:111]
  v_exp_f32 v154, v150
  v_exp_f32 v155, v151
  v_exp_f32 v156, v152
  v_exp_f32 v157, v153
  v_pk_add_f32 v[154:155], v[154:155], v[148:149]
  v_pk_add_f32 v[156:157], v[156:157], v[148:149]
  v_rcp_f32 v154, v154
  v_rcp_f32 v155, v155
  v_rcp_f32 v156, v156
  v_rcp_f32 v157, v157
  v_pk_mul_f32 v[154:155], v[154:155], v[108:109]
  v_pk_mul_f32 v[156:157], v[156:157], v[110:111]
  v_cvt_pk_bf16_f32 v50, v154, v155
  v_cvt_pk_bf16_f32 v51, v156, v157
  buffer_store_dwordx4 v[44:47], v9, s[12:15], s57 offen offset:2048 sc1
  buffer_store_dwordx4 v[48:51], v9, s[12:15], s57 offen offset:3072 sc1
  v_pk_fma_f32 v[112:113], v[112:113], v[62:63], v[28:29]
  v_pk_fma_f32 v[114:115], v[114:115], v[62:63], v[30:31]
  v_pk_fma_f32 v[116:117], v[116:117], v[62:63], v[32:33]
  v_pk_fma_f32 v[118:119], v[118:119], v[62:63], v[34:35]
  v_pk_fma_f32 v[120:121], v[120:121], v[62:63], v[36:37]
  v_pk_fma_f32 v[122:123], v[122:123], v[62:63], v[38:39]
  v_pk_fma_f32 v[124:125], v[124:125], v[62:63], v[40:41]
  v_pk_fma_f32 v[126:127], v[126:127], v[62:63], v[42:43]
  v_pk_mul_f32 v[150:151], v[112:113], v[112:113]
  v_pk_mul_f32 v[152:153], v[114:115], v[114:115]
  v_pk_fma_f32 v[150:151], v[150:151], v[146:147], v[144:145]
  v_pk_fma_f32 v[152:153], v[152:153], v[146:147], v[144:145]
  v_pk_mul_f32 v[150:151], v[150:151], v[112:113]
  v_pk_mul_f32 v[152:153], v[152:153], v[114:115]
  v_exp_f32 v154, v150
  v_exp_f32 v155, v151
  v_exp_f32 v156, v152
  v_exp_f32 v157, v153
  v_pk_add_f32 v[154:155], v[154:155], v[148:149]
  v_pk_add_f32 v[156:157], v[156:157], v[148:149]
  v_rcp_f32 v154, v154
  v_rcp_f32 v155, v155
  v_rcp_f32 v156, v156
  v_rcp_f32 v157, v157
  v_pk_mul_f32 v[154:155], v[154:155], v[112:113]
  v_pk_mul_f32 v[156:157], v[156:157], v[114:115]
  v_cvt_pk_bf16_f32 v52, v154, v155
  v_cvt_pk_bf16_f32 v53, v156, v157
  v_pk_mul_f32 v[150:151], v[116:117], v[116:117]
  v_pk_mul_f32 v[152:153], v[118:119], v[118:119]
  v_pk_fma_f32 v[150:151], v[150:151], v[146:147], v[144:145]
  v_pk_fma_f32 v[152:153], v[152:153], v[146:147], v[144:145]
  v_pk_mul_f32 v[150:151], v[150:151], v[116:117]
  v_pk_mul_f32 v[152:153], v[152:153], v[118:119]
  v_exp_f32 v154, v150
  v_exp_f32 v155, v151
  v_exp_f32 v156, v152
  v_exp_f32 v157, v153
  v_pk_add_f32 v[154:155], v[154:155], v[148:149]
  v_pk_add_f32 v[156:157], v[156:157], v[148:149]
  v_rcp_f32 v154, v154
  v_rcp_f32 v155, v155
  v_rcp_f32 v156, v156
  v_rcp_f32 v157, v157
  v_pk_mul_f32 v[154:155], v[154:155], v[116:117]
  v_pk_mul_f32 v[156:157], v[156:157], v[118:119]
  v_cvt_pk_bf16_f32 v54, v154, v155
  v_cvt_pk_bf16_f32 v55, v156, v157
  v_pk_mul_f32 v[150:151], v[120:121], v[120:121]
  v_pk_mul_f32 v[152:153], v[122:123], v[122:123]
  v_pk_fma_f32 v[150:151], v[150:151], v[146:147], v[144:145]
  v_pk_fma_f32 v[152:153], v[152:153], v[146:147], v[144:145]
  v_pk_mul_f32 v[150:151], v[150:151], v[120:121]
  v_pk_mul_f32 v[152:153], v[152:153], v[122:123]
  v_exp_f32 v154, v150
  v_exp_f32 v155, v151
  v_exp_f32 v156, v152
  v_exp_f32 v157, v153
  v_pk_add_f32 v[154:155], v[154:155], v[148:149]
  v_pk_add_f32 v[156:157], v[156:157], v[148:149]
  v_rcp_f32 v154, v154
  v_rcp_f32 v155, v155
  v_rcp_f32 v156, v156
  v_rcp_f32 v157, v157
  v_pk_mul_f32 v[154:155], v[154:155], v[120:121]
  v_pk_mul_f32 v[156:157], v[156:157], v[122:123]
  v_cvt_pk_bf16_f32 v56, v154, v155
  v_cvt_pk_bf16_f32 v57, v156, v157
  v_pk_mul_f32 v[150:151], v[124:125], v[124:125]
  v_pk_mul_f32 v[152:153], v[126:127], v[126:127]
  v_pk_fma_f32 v[150:151], v[150:151], v[146:147], v[144:145]
  v_pk_fma_f32 v[152:153], v[152:153], v[146:147], v[144:145]
  v_pk_mul_f32 v[150:151], v[150:151], v[124:125]
  v_pk_mul_f32 v[152:153], v[152:153], v[126:127]
  v_exp_f32 v154, v150
  v_exp_f32 v155, v151
  v_exp_f32 v156, v152
  v_exp_f32 v157, v153
  v_pk_add_f32 v[154:155], v[154:155], v[148:149]
  v_pk_add_f32 v[156:157], v[156:157], v[148:149]
  v_rcp_f32 v154, v154
  v_rcp_f32 v155, v155
  v_rcp_f32 v156, v156
  v_rcp_f32 v157, v157
  v_pk_mul_f32 v[154:155], v[154:155], v[124:125]
  v_pk_mul_f32 v[156:157], v[156:157], v[126:127]
  v_cvt_pk_bf16_f32 v58, v154, v155
  v_cvt_pk_bf16_f32 v59, v156, v157
  buffer_store_dwordx4 v[52:55], v9, s[12:15], s58 offen offset:2048 sc1
  buffer_store_dwordx4 v[56:59], v9, s[12:15], s58 offen offset:3072 sc1
  s_waitcnt vmcnt(0)
  s_mov_b64 exec, 1
  ds_add_rtn_u32 v10, v160, v161 offset:8
  s_waitcnt lgkmcnt(0)
  v_readfirstlane_b32 s35, v10
  s_nop 1
  s_cmp_lg_u32 s35, 3
  s_cbranch_scc1 fg_pubh
  buffer_atomic_add v161, off, s[12:15], s59 sc1
fg_pubh:
  s_mov_b64 exec, -1
  v_lshrrev_b32 v10, 2, v0
  v_lshlrev_b32 v10, 10, v10
  v_and_b32 v11, 3, v0
  v_lshl_add_u32 v10, v11, 7, v10
  s_mul_i32 s34, s31, 57344
  s_lshl_b32 s35, s32, 9
  s_add_u32 s34, s34, s35
  s_mul_i32 s35, s3, 14336
  s_add_u32 s34, s34, s35
  s_mov_b32 exec_hi, 0xffffff
  buffer_load_dword v11, v10, s[16:19], s34 offen
  s_mov_b32 exec_hi, -1
  s_branch fg_mlp2
fg_nomlp1:
  s_setprio 2
  s_cmp_lg_u32 s3, 0
  s_cbranch_scc1 fg_nocnt
  s_lshl_b32 s59, s28, 8
  s_add_u32 s59, s59, 17891328
  s_mov_b64 exec, 1
  buffer_atomic_add v161, off, s[12:15], s59 sc1
  s_mov_b64 exec, -1
fg_nocnt:
  s_mov_b64 exec, 1
  ds_add_u32 v160, v161 offset:40
  s_mov_b64 exec, -1
  s_mov_b32 s97, 0x40000
fg_idle:
  s_sleep 4
  ds_read_b32 v10, v160 offset:0
  s_sub_u32 s97, s97, 1
  s_cbranch_scc1 fg_idle_ok
  s_waitcnt lgkmcnt(0)
  v_readfirstlane_b32 s35, v10
  s_nop 1
  s_cmp_ge_u32 s35, 8
  s_cbranch_scc0 fg_idle
fg_idle_ok:
  s_waitcnt lgkmcnt(0)
fg_mlp2:
  s_mov_b32 s97, 0x40000
fg_xfree:
  ds_read_b32 v10, v160 offset:40
  s_sub_u32 s97, s97, 1
  s_cbranch_scc1 fg_xfree_ok
  s_waitcnt lgkmcnt(0)
  v_readfirstlane_b32 s35, v10
  s_nop 1
  s_cmp_ge_u32 s35, 4
  s_cbranch_scc0 fg_xfree
fg_xfree_ok:
  s_waitcnt lgkmcnt(0)
  s_lshl_b32 s6, s3, 14
  s_add_u32 s6, s6, 73728
  s_and_b32 s30, s2, 7
  s_lshr_b32 s31, s2, 3
  s_lshr_b32 s32, s30, 2
  s_and_b32 s34, s30, 3
  s_lshl_b32 s34, s34, 3
  s_and_b32 s7, s31, 7
  s_add_u32 s7, s7, s34
  s_lshl_b32 s8, s32, 2
  s_lshr_b32 s9, s31, 3
  s_add_u32 s8, s8, s9
  v_mov_b32 v154, 159744
  v_mov_b32 v155, 1
  v_lshrrev_b32 v150, 3, v0
  v_mul_u32_u24 v2, 1024, v150
  v_bfe_u32 v150, v0, 4, 1
  v_lshlrev_b32 v150, 2, v150
  v_and_b32 v151, 7, v0
  v_xor_b32 v150, v150, v151
  v_lshl_add_u32 v2, v150, 4, v2
  v_lshrrev_b32 v150, 5, v0
  v_lshlrev_b32 v150, 3, v150
  v_bfe_u32 v151, v0, 2, 2
  v_add_u32 v150, v150, v151
  v_mul_u32_u24 v3, 128, v150
  v_bfe_u32 v150, v0, 4, 1
  v_lshl_add_u32 v3, v150, 5, v3
  v_and_b32 v150, 1, v0
  v_lshl_add_u32 v3, v150, 4, v3
  v_bfe_u32 v150, v0, 1, 1
  v_lshl_add_u32 v3, v150, 3, v3
  v_bfe_u32 v150, v0, 3, 1
  v_lshl_add_u32 v3, v150, 6, v3
  v_add_u32 v3, s6, v3
  v_xor_b32 v4, 64, v3
  v_lshlrev_b32 v5, 4, v0
  s_mov_b32 s16, s76
  s_mov_b32 s17, s77
  s_mov_b32 s18, 0x1c0000
  s_mov_b32 s19, 0x20000
  s_mov_b32 s20, s68
  s_mov_b32 s21, s69
  s_mov_b32 s22, 0x80000
  s_mov_b32 s23, 0x20000
  s_mov_b32 s24, s82
  s_mov_b32 s25, s83
  s_mov_b32 s26, 0x200000
  s_mov_b32 s27, 0x20000
  s_mov_b32 s36, s78
  s_mov_b32 s37, s79
  s_mov_b32 s38, 0x400
  s_mov_b32 s39, 0x20000
  s_lshl_b32 s33, s8, 7
  s_mul_i32 s57, s3, 458752
  s_add_u32 s57, s57, s33
  s_mul_i32 s58, s7, 229376
  s_mul_i32 s34, s3, 28672
  s_add_u32 s58, s58, s34
  s_add_u32 s58, s58, 10485760
  s_lshl_b32 s40, s3, 17
  s_add_u32 s40, s40, s33
  s_lshl_b32 s41, s7, 16
  s_lshl_b32 s34, s3, 13
  s_add_u32 s41, s41, s34
  s_add_u32 s41, s41, 6291456
  v_lshrrev_b32 v151, 5, v0
  v_lshlrev_b32 v151, 4, v151
  s_lshr_b32 s34, s3, 1
  s_lshl_b32 s34, s34, 6
  s_add_u32 s34, s34, s33
  buffer_load_dwordx4 v[156:159], v151, s[36:39], s34 offen
  buffer_load_dwordx4 v[160:163], v151, s[36:39], s34 offen offset:32
  s_lshl_b32 s59, s7, 8
  s_add_u32 s59, s59, 17891328
  s_add_u32 m0, s6, 0
  s_add_u32 s56, s57, 8192
  buffer_load_dwordx4 v2, s[16:19], s57 offen lds
  s_add_u32 m0, s6, 1024
  s_add_u32 s57, s57, 16384
  buffer_load_dwordx4 v2, s[16:19], s56 offen lds
  s_add_u32 m0, s6, 2048
  s_add_u32 s56, s57, 8192
  buffer_load_dwordx4 v2, s[16:19], s57 offen lds
  s_add_u32 m0, s6, 3072
  s_add_u32 s57, s57, 16384
  buffer_load_dwordx4 v2, s[16:19], s56 offen lds
  s_add_u32 m0, s6, 4096
  s_add_u32 s56, s57, 8192
  buffer_load_dwordx4 v2, s[16:19], s57 offen lds
  s_add_u32 m0, s6, 5120
  s_add_u32 s57, s57, 16384
  buffer_load_dwordx4 v2, s[16:19], s56 offen lds
  s_add_u32 m0, s6, 6144
  s_add_u32 s56, s57, 8192
  buffer_load_dwordx4 v2, s[16:19], s57 offen lds
  s_add_u32 m0, s6, 7168
  s_add_u32 s57, s57, 16384
  buffer_load_dwordx4 v2, s[16:19], s56 offen lds
  s_add_u32 m0, s6, 8192
  s_add_u32 s56, s57, 8192
  buffer_load_dwordx4 v2, s[16:19], s57 offen lds
  s_add_u32 m0, s6, 9216
  s_add_u32 s57, s57, 16384
  buffer_load_dwordx4 v2, s[16:19], s56 offen lds
  s_add_u32 m0, s6, 10240
  s_add_u32 s56, s57, 8192
  buffer_load_dwordx4 v2, s[16:19], s57 offen lds
  s_add_u32 m0, s6, 11264
  s_add_u32 s57, s57, 16384
  buffer_load_dwordx4 v2, s[16:19], s56 offen lds
  s_add_u32 m0, s6, 12288
  s_add_u32 s56, s57, 8192
  buffer_load_dwordx4 v2, s[16:19], s57 offen lds
  s_add_u32 m0, s6, 13312
  s_add_u32 s57, s57, 16384
  buffer_load_dwordx4 v2, s[16:19], s56 offen lds
  s_add_u32 m0, s6, 14336
  s_add_u32 s56, s57, 8192
  buffer_load_dwordx4 v2, s[16:19], s57 offen lds
  s_add_u32 m0, s6, 15360
  s_add_u32 s57, s57, 16384
  buffer_load_dwordx4 v2, s[16:19], s56 offen lds
  v_lshrrev_b32 v150, 2, v0
  v_lshlrev_b32 v150, 10, v150
  v_and_b32 v151, 3, v0
  v_lshl_add_u32 v150, v151, 7, v150
  s_lshl_b32 s34, s31, 14
  s_lshl_b32 s35, s32, 9
  s_add_u32 s34, s34, s35
  s_cmp_lg_u32 s3, 1
  s_cbranch_scc1 fg_nopf
  buffer_load_dword v54, v150, s[20:23], s34 offen
fg_nopf:
  s_cmp_lg_u32 s3, 0
  s_cbranch_scc1 fg_wh_l
  v_lshlrev_b32 v150, 14, v0
  v_add_u32 v150, s59, v150
  v_add_u32 v151, 8, v0
  v_min_u32 v151, 8, v151
  s_mov_b64 exec, 3
  s_mov_b32 s97, 0x10000
fg_wh:
  buffer_load_dword v152, v150, s[12:15], 0 offen sc1
  s_waitcnt vmcnt(0)
  v_cmp_ge_u32 vcc, v152, v151
  s_sub_u32 s97, s97, 1
  s_cbranch_scc1 fg_wh_ok
  s_nop 1
  s_cmp_eq_u64 vcc, 3
  s_cbranch_scc1 fg_wh_ok
  s_sleep 2
  s_branch fg_wh
fg_wh_ok:
  s_mov_b64 exec, -1
  s_mov_b64 exec, 1
  ds_add_u32 v154, v155 offset:12
  s_mov_b64 exec, -1
  s_branch fg_wh_done
fg_wh_l:
  s_mov_b32 s97, 0x40000
fg_wh_lw:
  s_sleep 2
  ds_read_b32 v150, v154 offset:12
  s_sub_u32 s97, s97, 1
  s_cbranch_scc1 fg_wh_lw_ok
  s_waitcnt lgkmcnt(0)
  v_readfirstlane_b32 s35, v150
  s_nop 1
  s_cmp_ge_u32 s35, 1
  s_cbranch_scc0 fg_wh_lw
fg_wh_lw_ok:
  s_waitcnt lgkmcnt(0)
fg_wh_done:
  v_and_b32 v150, 31, v0
  v_lshlrev_b32 v150, 2, v150
  s_lshl_b32 s34, s7, 8
  s_add_u32 s34, s34, 17825792
  buffer_load_dword v152, v150, s[12:15], s34 offen sc1
  buffer_load_dword v153, v150, s[12:15], s34 offen offset:128 sc1
  s_add_u32 s56, s58, 114688
  buffer_load_dwordx4 v[22:25], v5, s[12:15], s58 offen sc1
  buffer_load_dwordx4 v[26:29], v5, s[12:15], s56 offen sc1
  s_add_u32 s58, s58, 1024
  s_add_u32 s56, s58, 114688
  buffer_load_dwordx4 v[30:33], v5, s[12:15], s58 offen sc1
  buffer_load_dwordx4 v[34:37], v5, s[12:15], s56 offen sc1
  s_add_u32 s58, s58, 1024
  s_add_u32 s56, s58, 114688
  buffer_load_dwordx4 v[38:41], v5, s[12:15], s58 offen sc1
  buffer_load_dwordx4 v[42:45], v5, s[12:15], s56 offen sc1
  s_add_u32 s58, s58, 1024
  s_add_u32 s56, s58, 114688
  buffer_load_dwordx4 v[46:49], v5, s[12:15], s58 offen sc1
  buffer_load_dwordx4 v[50:53], v5, s[12:15], s56 offen sc1
  s_add_u32 s58, s58, 1024
  s_add_u32 s56, s58, 114688
  buffer_load_dwordx4 v[54:57], v5, s[12:15], s58 offen sc1
  buffer_load_dwordx4 v[58:61], v5, s[12:15], s56 offen sc1
  s_add_u32 s58, s58, 1024
  s_add_u32 s56, s58, 114688
  buffer_load_dwordx4 v[62:65], v5, s[12:15], s58 offen sc1
  buffer_load_dwordx4 v[66:69], v5, s[12:15], s56 offen sc1
  s_add_u32 s58, s58, 1024
  s_add_u32 s56, s58, 114688
  buffer_load_dwordx4 v[70:73], v5, s[12:15], s58 offen sc1
  buffer_load_dwordx4 v[74:77], v5, s[12:15], s56 offen sc1
  s_add_u32 s58, s58, 1024
  s_add_u32 s56, s58, 114688
  buffer_load_dwordx4 v[78:81], v5, s[12:15], s58 offen sc1
  buffer_load_dwordx4 v[82:85], v5, s[12:15], s56 offen sc1
  s_add_u32 s58, s58, 1024
  s_setprio 0
  v_and_b32 v164, 1, v0
  v_lshlrev_b32 v164, 15, v164
  v_lshrrev_b32 v165, 1, v0
  v_lshl_add_u32 v164, v165, 10, v164
  v_add_u32 v164, 1020, v164
  v_mov_b32 v165, -1
  s_waitcnt vmcnt(16)
  ds_read_b64_tr_b16 v[6:7], v3 offset:0
  ds_read_b64_tr_b16 v[8:9], v3 offset:512
  ds_read_b64_tr_b16 v[10:11], v4 offset:0
  ds_read_b64_tr_b16 v[12:13], v4 offset:512
  s_waitcnt vmcnt(14) lgkmcnt(0)
  ds_read_b64_tr_b16 v[14:15], v3 offset:2048
  ds_read_b64_tr_b16 v[16:17], v3 offset:2560
  ds_read_b64_tr_b16 v[18:19], v4 offset:2048
  ds_read_b64_tr_b16 v[20:21], v4 offset:2560
  v_mfma_f32_32x32x16_bf16 v[86:101], v[6:9], v[22:25], 0
  v_mfma_f32_32x32x16_bf16 v[102:117], v[6:9], v[26:29], 0
  v_mfma_f32_32x32x16_bf16 v[118:133], v[10:13], v[22:25], 0
  v_mfma_f32_32x32x16_bf16 v[134:149], v[10:13], v[26:29], 0
  s_add_u32 m0, s6, 0
  s_add_u32 s56, s57, 8192
  buffer_load_dwordx4 v2, s[16:19], s57 offen lds
  s_add_u32 m0, s6, 1024
  s_add_u32 s57, s57, 16384
  buffer_load_dwordx4 v2, s[16:19], s56 offen lds
  s_add_u32 s56, s58, 114688
  buffer_load_dwordx4 v[22:25], v5, s[12:15], s58 offen sc1
  buffer_load_dwordx4 v[26:29], v5, s[12:15], s56 offen sc1
  s_add_u32 s58, s58, 1024
  s_waitcnt vmcnt(16) lgkmcnt(0)
  ds_read_b64_tr_b16 v[6:7], v3 offset:4096
  ds_read_b64_tr_b16 v[8:9], v3 offset:4608
  ds_read_b64_tr_b16 v[10:11], v4 offset:4096
  ds_read_b64_tr_b16 v[12:13], v4 offset:4608
  v_mfma_f32_32x32x16_bf16 v[86:101], v[14:17], v[30:33], v[86:101]
  v_mfma_f32_32x32x16_bf16 v[102:117], v[14:17], v[34:37], v[102:117]
  v_mfma_f32_32x32x16_bf16 v[118:133], v[18:21], v[30:33], v[118:133]
  v_mfma_f32_32x32x16_bf16 v[134:149], v[18:21], v[34:37], v[134:149]
  s_add_u32 m0, s6, 2048
  s_add_u32 s56, s57, 8192
  buffer_load_dwordx4 v2, s[16:19], s57 offen lds
  s_add_u32 m0, s6, 3072
  s_add_u32 s57, s57, 16384
  buffer_load_dwordx4 v2, s[16:19], s56 offen lds
  s_add_u32 s56, s58, 114688
  buffer_load_dwordx4 v[30:33], v5, s[12:15], s58 offen sc1
  buffer_load_dwordx4 v[34:37], v5, s[12:15], s56 offen sc1
  s_add_u32 s58, s58, 1024
  s_waitcnt vmcnt(18) lgkmcnt(0)
  ds_read_b64_tr_b16 v[14:15], v3 offset:6144
  ds_read_b64_tr_b16 v[16:17], v3 offset:6656
  ds_read_b64_tr_b16 v[18:19], v4 offset:6144
  ds_read_b64_tr_b16 v[20:21], v4 offset:6656
  v_mfma_f32_32x32x16_bf16 v[86:101], v[6:9], v[38:41], v[86:101]
  v_mfma_f32_32x32x16_bf16 v[102:117], v[6:9], v[42:45], v[102:117]
  v_mfma_f32_32x32x16_bf16 v[118:133], v[10:13], v[38:41], v[118:133]
  v_mfma_f32_32x32x16_bf16 v[134:149], v[10:13], v[42:45], v[134:149]
  s_add_u32 m0, s6, 4096
  s_add_u32 s56, s57, 8192
  buffer_load_dwordx4 v2, s[16:19], s57 offen lds
  s_add_u32 m0, s6, 5120
  s_add_u32 s57, s57, 16384
  buffer_load_dwordx4 v2, s[16:19], s56 offen lds
  s_add_u32 s56, s58, 114688
  buffer_load_dwordx4 v[38:41], v5, s[12:15], s58 offen sc1
  buffer_load_dwordx4 v[42:45], v5, s[12:15], s56 offen sc1
  s_add_u32 s58, s58, 1024
  s_waitcnt vmcnt(20) lgkmcnt(0)
  ds_read_b64_tr_b16 v[6:7], v3 offset:8192
  ds_read_b64_tr_b16 v[8:9], v3 offset:8704
  ds_read_b64_tr_b16 v[10:11], v4 offset:8192
  ds_read_b64_tr_b16 v[12:13], v4 offset:8704
  v_mfma_f32_32x32x16_bf16 v[86:101], v[14:17], v[46:49], v[86:101]
  v_mfma_f32_32x32x16_bf16 v[102:117], v[14:17], v[50:53], v[102:117]
  v_mfma_f32_32x32x16_bf16 v[118:133], v[18:21], v[46:49], v[118:133]
  v_mfma_f32_32x32x16_bf16 v[134:149], v[18:21], v[50:53], v[134:149]
  s_add_u32 m0, s6, 6144
  s_add_u32 s56, s57, 8192
  buffer_load_dwordx4 v2, s[16:19], s57 offen lds
  s_add_u32 m0, s6, 7168
  s_add_u32 s57, s57, 16384
  buffer_load_dwordx4 v2, s[16:19], s56 offen lds
  s_add_u32 s56, s58, 114688
  buffer_load_dwordx4 v[46:49], v5, s[12:15], s58 offen sc1
  buffer_load_dwordx4 v[50:53], v5, s[12:15], s56 offen sc1
  s_add_u32 s58, s58, 1024
  s_waitcnt vmcnt(22) lgkmcnt(0)
  ds_read_b64_tr_b16 v[14:15], v3 offset:10240
  ds_read_b64_tr_b16 v[16:17], v3 offset:10752
  ds_read_b64_tr_b16 v[18:19], v4 offset:10240
  ds_read_b64_tr_b16 v[20:21], v4 offset:10752
  v_mfma_f32_32x32x16_bf16 v[86:101], v[6:9], v[54:57], v[86:101]
  v_mfma_f32_32x32x16_bf16 v[102:117], v[6:9], v[58:61], v[102:117]
  v_mfma_f32_32x32x16_bf16 v[118:133], v[10:13], v[54:57], v[118:133]
  v_mfma_f32_32x32x16_bf16 v[134:149], v[10:13], v[58:61], v[134:149]
  s_add_u32 m0, s6, 8192
  s_add_u32 s56, s57, 8192
  buffer_load_dwordx4 v2, s[16:19], s57 offen lds
  s_add_u32 m0, s6, 9216
  s_add_u32 s57, s57, 16384
  buffer_load_dwordx4 v2, s[16:19], s56 offen lds
  s_add_u32 s56, s58, 114688
  buffer_load_dwordx4 v[54:57], v5, s[12:15], s58 offen sc1
  buffer_load_dwordx4 v[58:61], v5, s[12:15], s56 offen sc1
  s_add_u32 s58, s58, 1024
  s_waitcnt vmcnt(24) lgkmcnt(0)
  ds_read_b64_tr_b16 v[6:7], v3 offset:12288
  ds_read_b64_tr_b16 v[8:9], v3 offset:12800
  ds_read_b64_tr_b16 v[10:11], v4 offset:12288
  ds_read_b64_tr_b16 v[12:13], v4 offset:12800
  v_mfma_f32_32x32x16_bf16 v[86:101], v[14:17], v[62:65], v[86:101]
  v_mfma_f32_32x32x16_bf16 v[102:117], v[14:17], v[66:69], v[102:117]
  v_mfma_f32_32x32x16_bf16 v[118:133], v[18:21], v[62:65], v[118:133]
  v_mfma_f32_32x32x16_bf16 v[134:149], v[18:21], v[66:69], v[134:149]
  s_add_u32 m0, s6, 10240
  s_add_u32 s56, s57, 8192
  buffer_load_dwordx4 v2, s[16:19], s57 offen lds
  s_add_u32 m0, s6, 11264
  s_add_u32 s57, s57, 16384
  buffer_load_dwordx4 v2, s[16:19], s56 offen lds
  s_add_u32 s56, s58, 114688
  buffer_load_dwordx4 v[62:65], v5, s[12:15], s58 offen sc1
  buffer_load_dwordx4 v[66:69], v5, s[12:15], s56 offen sc1
  s_add_u32 s58, s58, 1024
  s_waitcnt vmcnt(26) lgkmcnt(0)
  ds_read_b64_tr_b16 v[14:15], v3 offset:14336
  ds_read_b64_tr_b16 v[16:17], v3 offset:14848
  ds_read_b64_tr_b16 v[18:19], v4 offset:14336
  ds_read_b64_tr_b16 v[20:21], v4 offset:14848
  v_mfma_f32_32x32x16_bf16 v[86:101], v[6:9], v[70:73], v[86:101]
  v_mfma_f32_32x32x16_bf16 v[102:117], v[6:9], v[74:77], v[102:117]
  v_mfma_f32_32x32x16_bf16 v[118:133], v[10:13], v[70:73], v[118:133]
  v_mfma_f32_32x32x16_bf16 v[134:149], v[10:13], v[74:77], v[134:149]
  s_add_u32 m0, s6, 12288
  s_add_u32 s56, s57, 8192
  buffer_load_dwordx4 v2, s[16:19], s57 offen lds
  s_add_u32 m0, s6, 13312
  s_add_u32 s57, s57, 16384
  buffer_load_dwordx4 v2, s[16:19], s56 offen lds
  s_add_u32 s56, s58, 114688
  buffer_load_dwordx4 v[70:73], v5, s[12:15], s58 offen sc1
  buffer_load_dwordx4 v[74:77], v5, s[12:15], s56 offen sc1
  s_add_u32 s58, s58, 1024
  s_waitcnt vmcnt(26) lgkmcnt(0)
  ds_read_b64_tr_b16 v[6:7], v3 offset:0
  ds_read_b64_tr_b16 v[8:9], v3 offset:512
  ds_read_b64_tr_b16 v[10:11], v4 offset:0
  ds_read_b64_tr_b16 v[12:13], v4 offset:512
  v_mfma_f32_32x32x16_bf16 v[86:101], v[14:17], v[78:81], v[86:101]
  v_mfma_f32_32x32x16_bf16 v[102:117], v[14:17], v[82:85], v[102:117]
  v_mfma_f32_32x32x16_bf16 v[118:133], v[18:21], v[78:81], v[118:133]
  v_mfma_f32_32x32x16_bf16 v[134:149], v[18:21], v[82:85], v[134:149]
  s_add_u32 m0, s6, 14336
  s_add_u32 s56, s57, 8192
  buffer_load_dwordx4 v2, s[16:19], s57 offen lds
  s_add_u32 m0, s6, 15360
  s_add_u32 s57, s57, 16384
  buffer_load_dwordx4 v2, s[16:19], s56 offen lds
  s_add_u32 s56, s58, 114688
  buffer_load_dwordx4 v[78:81], v5, s[12:15], s58 offen sc1
  buffer_load_dwordx4 v[82:85], v5, s[12:15], s56 offen sc1
  s_add_u32 s58, s58, 1024
  s_waitcnt vmcnt(26) lgkmcnt(0)
  ds_read_b64_tr_b16 v[14:15], v3 offset:2048
  ds_read_b64_tr_b16 v[16:17], v3 offset:2560
  ds_read_b64_tr_b16 v[18:19], v4 offset:2048
  ds_read_b64_tr_b16 v[20:21], v4 offset:2560
  v_mfma_f32_32x32x16_bf16 v[86:101], v[6:9], v[22:25], v[86:101]
  v_mfma_f32_32x32x16_bf16 v[102:117], v[6:9], v[26:29], v[102:117]
  v_mfma_f32_32x32x16_bf16 v[118:133], v[10:13], v[22:25], v[118:133]
  v_mfma_f32_32x32x16_bf16 v[134:149], v[10:13], v[26:29], v[134:149]
  s_add_u32 m0, s6, 0
  s_add_u32 s56, s57, 8192
  buffer_load_dwordx4 v2, s[16:19], s57 offen lds
  s_add_u32 m0, s6, 1024
  s_add_u32 s57, s57, 16384
  buffer_load_dwordx4 v2, s[16:19], s56 offen lds
  s_add_u32 s56, s58, 114688
  buffer_load_dwordx4 v[22:25], v5, s[12:15], s58 offen sc1
  buffer_load_dwordx4 v[26:29], v5, s[12:15], s56 offen sc1
  s_add_u32 s58, s58, 1024
  s_waitcnt vmcnt(26) lgkmcnt(0)
  ds_read_b64_tr_b16 v[6:7], v3 offset:4096
  ds_read_b64_tr_b16 v[8:9], v3 offset:4608
  ds_read_b64_tr_b16 v[10:11], v4 offset:4096
  ds_read_b64_tr_b16 v[12:13], v4 offset:4608
  v_mfma_f32_32x32x16_bf16 v[86:101], v[14:17], v[30:33], v[86:101]
  v_mfma_f32_32x32x16_bf16 v[102:117], v[14:17], v[34:37], v[102:117]
  v_mfma_f32_32x32x16_bf16 v[118:133], v[18:21], v[30:33], v[118:133]
  v_mfma_f32_32x32x16_bf16 v[134:149], v[18:21], v[34:37], v[134:149]
  s_add_u32 m0, s6, 2048
  s_add_u32 s56, s57, 8192
  buffer_load_dwordx4 v2, s[16:19], s57 offen lds
  s_add_u32 m0, s6, 3072
  s_add_u32 s57, s57, 16384
  buffer_load_dwordx4 v2, s[16:19], s56 offen lds
  s_add_u32 s56, s58, 114688
  buffer_load_dwordx4 v[30:33], v5, s[12:15], s58 offen sc1
  buffer_load_dwordx4 v[34:37], v5, s[12:15], s56 offen sc1
  s_add_u32 s58, s58, 1024
  s_waitcnt vmcnt(26) lgkmcnt(0)
  ds_read_b64_tr_b16 v[14:15], v3 offset:6144
  ds_read_b64_tr_b16 v[16:17], v3 offset:6656
  ds_read_b64_tr_b16 v[18:19], v4 offset:6144
  ds_read_b64_tr_b16 v[20:21], v4 offset:6656
  v_mfma_f32_32x32x16_bf16 v[86:101], v[6:9], v[38:41], v[86:101]
  v_mfma_f32_32x32x16_bf16 v[102:117], v[6:9], v[42:45], v[102:117]
  v_mfma_f32_32x32x16_bf16 v[118:133], v[10:13], v[38:41], v[118:133]
  v_mfma_f32_32x32x16_bf16 v[134:149], v[10:13], v[42:45], v[134:149]
  s_add_u32 m0, s6, 4096
  s_add_u32 s56, s57, 8192
  buffer_load_dwordx4 v2, s[16:19], s57 offen lds
  s_add_u32 m0, s6, 5120
  s_add_u32 s57, s57, 16384
  buffer_load_dwordx4 v2, s[16:19], s56 offen lds
  s_add_u32 s56, s58, 114688
  buffer_load_dwordx4 v[38:41], v5, s[12:15], s58 offen sc1
  buffer_load_dwordx4 v[42:45], v5, s[12:15], s56 offen sc1
  s_add_u32 s58, s58, 1024
  s_waitcnt vmcnt(26) lgkmcnt(0)
  ds_read_b64_tr_b16 v[6:7], v3 offset:8192
  ds_read_b64_tr_b16 v[8:9], v3 offset:8704
  ds_read_b64_tr_b16 v[10:11], v4 offset:8192
  ds_read_b64_tr_b16 v[12:13], v4 offset:8704
  v_mfma_f32_32x32x16_bf16 v[86:101], v[14:17], v[46:49], v[86:101]
  v_mfma_f32_32x32x16_bf16 v[102:117], v[14:17], v[50:53], v[102:117]
  v_mfma_f32_32x32x16_bf16 v[118:133], v[18:21], v[46:49], v[118:133]
  v_mfma_f32_32x32x16_bf16 v[134:149], v[18:21], v[50:53], v[134:149]
  s_add_u32 m0, s6, 6144
  s_add_u32 s56, s57, 8192
  buffer_load_dwordx4 v2, s[16:19], s57 offen lds
  s_add_u32 m0, s6, 7168
  s_add_u32 s57, s57, 16384
  buffer_load_dwordx4 v2, s[16:19], s56 offen lds
  s_add_u32 s56, s58, 114688
  buffer_load_dwordx4 v[46:49], v5, s[12:15], s58 offen sc1
  buffer_load_dwordx4 v[50:53], v5, s[12:15], s56 offen sc1
  s_add_u32 s58, s58, 1024
  s_waitcnt vmcnt(26) lgkmcnt(0)
  ds_read_b64_tr_b16 v[14:15], v3 offset:10240
  ds_read_b64_tr_b16 v[16:17], v3 offset:10752
  ds_read_b64_tr_b16 v[18:19], v4 offset:10240
  ds_read_b64_tr_b16 v[20:21], v4 offset:10752
  v_mfma_f32_32x32x16_bf16 v[86:101], v[6:9], v[54:57], v[86:101]
  v_mfma_f32_32x32x16_bf16 v[102:117], v[6:9], v[58:61], v[102:117]
  v_mfma_f32_32x32x16_bf16 v[118:133], v[10:13], v[54:57], v[118:133]
  v_mfma_f32_32x32x16_bf16 v[134:149], v[10:13], v[58:61], v[134:149]
  s_add_u32 m0, s6, 8192
  s_add_u32 s56, s57, 8192
  buffer_load_dwordx4 v2, s[16:19], s57 offen lds
  s_add_u32 m0, s6, 9216
  s_add_u32 s57, s57, 16384
  buffer_load_dwordx4 v2, s[16:19], s56 offen lds
  s_add_u32 s56, s58, 114688
  buffer_load_dwordx4 v[54:57], v5, s[12:15], s58 offen sc1
  buffer_load_dwordx4 v[58:61], v5, s[12:15], s56 offen sc1
  s_add_u32 s58, s58, 1024
  s_waitcnt vmcnt(26) lgkmcnt(0)
  ds_read_b64_tr_b16 v[6:7], v3 offset:12288
  ds_read_b64_tr_b16 v[8:9], v3 offset:12800
  ds_read_b64_tr_b16 v[10:11], v4 offset:12288
  ds_read_b64_tr_b16 v[12:13], v4 offset:12800
  v_mfma_f32_32x32x16_bf16 v[86:101], v[14:17], v[62:65], v[86:101]
  v_mfma_f32_32x32x16_bf16 v[102:117], v[14:17], v[66:69], v[102:117]
  v_mfma_f32_32x32x16_bf16 v[118:133], v[18:21], v[62:65], v[118:133]
  v_mfma_f32_32x32x16_bf16 v[134:149], v[18:21], v[66:69], v[134:149]
  s_add_u32 m0, s6, 10240
  s_add_u32 s56, s57, 8192
  buffer_load_dwordx4 v2, s[16:19], s57 offen lds
  s_add_u32 m0, s6, 11264
  s_add_u32 s57, s57, 16384
  buffer_load_dwordx4 v2, s[16:19], s56 offen lds
  s_add_u32 s56, s58, 114688
  buffer_load_dwordx4 v[62:65], v5, s[12:15], s58 offen sc1
  buffer_load_dwordx4 v[66:69], v5, s[12:15], s56 offen sc1
  s_add_u32 s58, s58, 1024
  s_waitcnt vmcnt(26) lgkmcnt(0)
  ds_read_b64_tr_b16 v[14:15], v3 offset:14336
  ds_read_b64_tr_b16 v[16:17], v3 offset:14848
  ds_read_b64_tr_b16 v[18:19], v4 offset:14336
  ds_read_b64_tr_b16 v[20:21], v4 offset:14848
  v_mfma_f32_32x32x16_bf16 v[86:101], v[6:9], v[70:73], v[86:101]
  v_mfma_f32_32x32x16_bf16 v[102:117], v[6:9], v[74:77], v[102:117]
  v_mfma_f32_32x32x16_bf16 v[118:133], v[10:13], v[70:73], v[118:133]
  v_mfma_f32_32x32x16_bf16 v[134:149], v[10:13], v[74:77], v[134:149]
  s_add_u32 m0, s6, 12288
  s_add_u32 s56, s57, 8192
  buffer_load_dwordx4 v2, s[16:19], s57 offen lds
  s_add_u32 m0, s6, 13312
  s_add_u32 s57, s57, 16384
  buffer_load_dwordx4 v2, s[16:19], s56 offen lds
  s_add_u32 s56, s58, 114688
  buffer_load_dwordx4 v[70:73], v5, s[12:15], s58 offen sc1
  buffer_load_dwordx4 v[74:77], v5, s[12:15], s56 offen sc1
  s_add_u32 s58, s58, 1024
  s_waitcnt vmcnt(26) lgkmcnt(0)
  ds_read_b64_tr_b16 v[6:7], v3 offset:0
  ds_read_b64_tr_b16 v[8:9], v3 offset:512
  ds_read_b64_tr_b16 v[10:11], v4 offset:0
  ds_read_b64_tr_b16 v[12:13], v4 offset:512
  v_mfma_f32_32x32x16_bf16 v[86:101], v[14:17], v[78:81], v[86:101]
  v_mfma_f32_32x32x16_bf16 v[102:117], v[14:17], v[82:85], v[102:117]
  v_mfma_f32_32x32x16_bf16 v[118:133], v[18:21], v[78:81], v[118:133]
  v_mfma_f32_32x32x16_bf16 v[134:149], v[18:21], v[82:85], v[134:149]
  s_add_u32 m0, s6, 14336
  s_add_u32 s56, s57, 8192
  buffer_load_dwordx4 v2, s[16:19], s57 offen lds
  s_add_u32 m0, s6, 15360
  s_add_u32 s57, s57, 16384
  buffer_load_dwordx4 v2, s[16:19], s56 offen lds
  s_add_u32 s56, s58, 114688
  buffer_load_dwordx4 v[78:81], v5, s[12:15], s58 offen sc1
  buffer_load_dwordx4 v[82:85], v5, s[12:15], s56 offen sc1
  s_add_u32 s58, s58, 1024
  s_waitcnt vmcnt(26) lgkmcnt(0)
  ds_read_b64_tr_b16 v[14:15], v3 offset:2048
  ds_read_b64_tr_b16 v[16:17], v3 offset:2560
  ds_read_b64_tr_b16 v[18:19], v4 offset:2048
  ds_read_b64_tr_b16 v[20:21], v4 offset:2560
  v_mfma_f32_32x32x16_bf16 v[86:101], v[6:9], v[22:25], v[86:101]
  v_mfma_f32_32x32x16_bf16 v[102:117], v[6:9], v[26:29], v[102:117]
  v_mfma_f32_32x32x16_bf16 v[118:133], v[10:13], v[22:25], v[118:133]
  v_mfma_f32_32x32x16_bf16 v[134:149], v[10:13], v[26:29], v[134:149]
  s_add_u32 m0, s6, 0
  s_add_u32 s56, s57, 8192
  buffer_load_dwordx4 v2, s[16:19], s57 offen lds
  s_add_u32 m0, s6, 1024
  s_add_u32 s57, s57, 16384
  buffer_load_dwordx4 v2, s[16:19], s56 offen lds
  s_add_u32 s56, s58, 114688
  buffer_load_dwordx4 v[22:25], v5, s[12:15], s58 offen sc1
  buffer_load_dwordx4 v[26:29], v5, s[12:15], s56 offen sc1
  s_add_u32 s58, s58, 1024
  s_waitcnt vmcnt(26) lgkmcnt(0)
  ds_read_b64_tr_b16 v[6:7], v3 offset:4096
  ds_read_b64_tr_b16 v[8:9], v3 offset:4608
  ds_read_b64_tr_b16 v[10:11], v4 offset:4096
  ds_read_b64_tr_b16 v[12:13], v4 offset:4608
  v_mfma_f32_32x32x16_bf16 v[86:101], v[14:17], v[30:33], v[86:101]
  v_mfma_f32_32x32x16_bf16 v[102:117], v[14:17], v[34:37], v[102:117]
  v_mfma_f32_32x32x16_bf16 v[118:133], v[18:21], v[30:33], v[118:133]
  v_mfma_f32_32x32x16_bf16 v[134:149], v[18:21], v[34:37], v[134:149]
  s_add_u32 m0, s6, 2048
  s_add_u32 s56, s57, 8192
  buffer_load_dwordx4 v2, s[16:19], s57 offen lds
  s_add_u32 m0, s6, 3072
  s_add_u32 s57, s57, 16384
  buffer_load_dwordx4 v2, s[16:19], s56 offen lds
  s_add_u32 s56, s58, 114688
  buffer_load_dwordx4 v[30:33], v5, s[12:15], s58 offen sc1
  buffer_load_dwordx4 v[34:37], v5, s[12:15], s56 offen sc1
  s_add_u32 s58, s58, 1024
  s_waitcnt vmcnt(26) lgkmcnt(0)
  ds_read_b64_tr_b16 v[14:15], v3 offset:6144
  ds_read_b64_tr_b16 v[16:17], v3 offset:6656
  ds_read_b64_tr_b16 v[18:19], v4 offset:6144
  ds_read_b64_tr_b16 v[20:21], v4 offset:6656
  v_mfma_f32_32x32x16_bf16 v[86:101], v[6:9], v[38:41], v[86:101]
  v_mfma_f32_32x32x16_bf16 v[102:117], v[6:9], v[42:45], v[102:117]
  v_mfma_f32_32x32x16_bf16 v[118:133], v[10:13], v[38:41], v[118:133]
  v_mfma_f32_32x32x16_bf16 v[134:149], v[10:13], v[42:45], v[134:149]
  s_add_u32 m0, s6, 4096
  s_add_u32 s56, s57, 8192
  buffer_load_dwordx4 v2, s[16:19], s57 offen lds
  s_add_u32 m0, s6, 5120
  s_add_u32 s57, s57, 16384
  buffer_load_dwordx4 v2, s[16:19], s56 offen lds
  s_add_u32 s56, s58, 114688
  buffer_load_dwordx4 v[38:41], v5, s[12:15], s58 offen sc1
  buffer_load_dwordx4 v[42:45], v5, s[12:15], s56 offen sc1
  s_add_u32 s58, s58, 1024
  s_waitcnt vmcnt(26) lgkmcnt(0)
  ds_read_b64_tr_b16 v[6:7], v3 offset:8192
  ds_read_b64_tr_b16 v[8:9], v3 offset:8704
  ds_read_b64_tr_b16 v[10:11], v4 offset:8192
  ds_read_b64_tr_b16 v[12:13], v4 offset:8704
  v_mfma_f32_32x32x16_bf16 v[86:101], v[14:17], v[46:49], v[86:101]
  v_mfma_f32_32x32x16_bf16 v[102:117], v[14:17], v[50:53], v[102:117]
  v_mfma_f32_32x32x16_bf16 v[118:133], v[18:21], v[46:49], v[118:133]
  v_mfma_f32_32x32x16_bf16 v[134:149], v[18:21], v[50:53], v[134:149]
  s_add_u32 m0, s6, 6144
  s_add_u32 s56, s57, 8192
  buffer_load_dwordx4 v2, s[16:19], s57 offen lds
  s_add_u32 m0, s6, 7168
  s_add_u32 s57, s57, 16384
  buffer_load_dwordx4 v2, s[16:19], s56 offen lds
  s_add_u32 s56, s58, 114688
  buffer_load_dwordx4 v[46:49], v5, s[12:15], s58 offen sc1
  buffer_load_dwordx4 v[50:53], v5, s[12:15], s56 offen sc1
  s_add_u32 s58, s58, 1024
  s_waitcnt vmcnt(26) lgkmcnt(0)
  ds_read_b64_tr_b16 v[14:15], v3 offset:10240
  ds_read_b64_tr_b16 v[16:17], v3 offset:10752
  ds_read_b64_tr_b16 v[18:19], v4 offset:10240
  ds_read_b64_tr_b16 v[20:21], v4 offset:10752
  v_mfma_f32_32x32x16_bf16 v[86:101], v[6:9], v[54:57], v[86:101]
  v_mfma_f32_32x32x16_bf16 v[102:117], v[6:9], v[58:61], v[102:117]
  v_mfma_f32_32x32x16_bf16 v[118:133], v[10:13], v[54:57], v[118:133]
  v_mfma_f32_32x32x16_bf16 v[134:149], v[10:13], v[58:61], v[134:149]
  s_add_u32 m0, s6, 8192
  s_add_u32 s56, s40, 8192
  buffer_load_dwordx4 v2, s[20:23], s40 offen lds
  s_add_u32 m0, s6, 9216
  s_add_u32 s40, s40, 16384
  buffer_load_dwordx4 v2, s[20:23], s56 offen lds
  s_waitcnt vmcnt(24) lgkmcnt(0)
  ds_read_b64_tr_b16 v[6:7], v3 offset:12288
  ds_read_b64_tr_b16 v[8:9], v3 offset:12800
  ds_read_b64_tr_b16 v[10:11], v4 offset:12288
  ds_read_b64_tr_b16 v[12:13], v4 offset:12800
  v_mfma_f32_32x32x16_bf16 v[86:101], v[14:17], v[62:65], v[86:101]
  v_mfma_f32_32x32x16_bf16 v[102:117], v[14:17], v[66:69], v[102:117]
  v_mfma_f32_32x32x16_bf16 v[118:133], v[18:21], v[62:65], v[118:133]
  v_mfma_f32_32x32x16_bf16 v[134:149], v[18:21], v[66:69], v[134:149]
  s_add_u32 m0, s6, 10240
  s_add_u32 s56, s40, 8192
  buffer_load_dwordx4 v2, s[20:23], s40 offen lds
  s_add_u32 m0, s6, 11264
  s_add_u32 s40, s40, 16384
  buffer_load_dwordx4 v2, s[20:23], s56 offen lds
  s_waitcnt vmcnt(22) lgkmcnt(0)
  ds_read_b64_tr_b16 v[14:15], v3 offset:14336
  ds_read_b64_tr_b16 v[16:17], v3 offset:14848
  ds_read_b64_tr_b16 v[18:19], v4 offset:14336
  ds_read_b64_tr_b16 v[20:21], v4 offset:14848
  v_mfma_f32_32x32x16_bf16 v[86:101], v[6:9], v[70:73], v[86:101]
  v_mfma_f32_32x32x16_bf16 v[102:117], v[6:9], v[74:77], v[102:117]
  v_mfma_f32_32x32x16_bf16 v[118:133], v[10:13], v[70:73], v[118:133]
  v_mfma_f32_32x32x16_bf16 v[134:149], v[10:13], v[74:77], v[134:149]
  s_add_u32 m0, s6, 12288
  s_add_u32 s56, s40, 8192
  buffer_load_dwordx4 v2, s[20:23], s40 offen lds
  s_add_u32 m0, s6, 13312
  s_add_u32 s40, s40, 16384
  buffer_load_dwordx4 v2, s[20:23], s56 offen lds
  s_waitcnt vmcnt(20) lgkmcnt(0)
  ds_read_b64_tr_b16 v[6:7], v3 offset:0
  ds_read_b64_tr_b16 v[8:9], v3 offset:512
  ds_read_b64_tr_b16 v[10:11], v4 offset:0
  ds_read_b64_tr_b16 v[12:13], v4 offset:512
  v_mfma_f32_32x32x16_bf16 v[86:101], v[14:17], v[78:81], v[86:101]
  v_mfma_f32_32x32x16_bf16 v[102:117], v[14:17], v[82:85], v[102:117]
  v_mfma_f32_32x32x16_bf16 v[118:133], v[18:21], v[78:81], v[118:133]
  v_mfma_f32_32x32x16_bf16 v[134:149], v[18:21], v[82:85], v[134:149]
  s_add_u32 m0, s6, 14336
  s_add_u32 s56, s40, 8192
  buffer_load_dwordx4 v2, s[20:23], s40 offen lds
  s_add_u32 m0, s6, 15360
  s_add_u32 s40, s40, 16384
  buffer_load_dwordx4 v2, s[20:23], s56 offen lds
  s_waitcnt vmcnt(18) lgkmcnt(0)
  ds_read_b64_tr_b16 v[14:15], v3 offset:2048
  ds_read_b64_tr_b16 v[16:17], v3 offset:2560
  ds_read_b64_tr_b16 v[18:19], v4 offset:2048
  ds_read_b64_tr_b16 v[20:21], v4 offset:2560
  v_mfma_f32_32x32x16_bf16 v[86:101], v[6:9], v[22:25], v[86:101]
  v_mfma_f32_32x32x16_bf16 v[102:117], v[6:9], v[26:29], v[102:117]
  v_mfma_f32_32x32x16_bf16 v[118:133], v[10:13], v[22:25], v[118:133]
  v_mfma_f32_32x32x16_bf16 v[134:149], v[10:13], v[26:29], v[134:149]
  s_add_u32 m0, s6, 0
  s_add_u32 s56, s40, 8192
  buffer_load_dwordx4 v2, s[20:23], s40 offen lds
  s_add_u32 m0, s6, 1024
  s_add_u32 s40, s40, 16384
  buffer_load_dwordx4 v2, s[20:23], s56 offen lds
  s_waitcnt vmcnt(16) lgkmcnt(0)
  ds_read_b64_tr_b16 v[6:7], v3 offset:4096
  ds_read_b64_tr_b16 v[8:9], v3 offset:4608
  ds_read_b64_tr_b16 v[10:11], v4 offset:4096
  ds_read_b64_tr_b16 v[12:13], v4 offset:4608
  v_mfma_f32_32x32x16_bf16 v[86:101], v[14:17], v[30:33], v[86:101]
  v_mfma_f32_32x32x16_bf16 v[102:117], v[14:17], v[34:37], v[102:117]
  v_mfma_f32_32x32x16_bf16 v[118:133], v[18:21], v[30:33], v[118:133]
  v_mfma_f32_32x32x16_bf16 v[134:149], v[18:21], v[34:37], v[134:149]
  s_add_u32 m0, s6, 2048
  s_add_u32 s56, s40, 8192
  buffer_load_dwordx4 v2, s[20:23], s40 offen lds
  s_add_u32 m0, s6, 3072
  s_add_u32 s40, s40, 16384
  buffer_load_dwordx4 v2, s[20:23], s56 offen lds
  s_waitcnt vmcnt(14) lgkmcnt(0)
  ds_read_b64_tr_b16 v[14:15], v3 offset:6144
  ds_read_b64_tr_b16 v[16:17], v3 offset:6656
  ds_read_b64_tr_b16 v[18:19], v4 offset:6144
  ds_read_b64_tr_b16 v[20:21], v4 offset:6656
  v_mfma_f32_32x32x16_bf16 v[86:101], v[6:9], v[38:41], v[86:101]
  v_mfma_f32_32x32x16_bf16 v[102:117], v[6:9], v[42:45], v[102:117]
  v_mfma_f32_32x32x16_bf16 v[118:133], v[10:13], v[38:41], v[118:133]
  v_mfma_f32_32x32x16_bf16 v[134:149], v[10:13], v[42:45], v[134:149]
  s_add_u32 m0, s6, 4096
  s_add_u32 s56, s40, 8192
  buffer_load_dwordx4 v2, s[20:23], s40 offen lds
  s_add_u32 m0, s6, 5120
  s_add_u32 s40, s40, 16384
  buffer_load_dwordx4 v2, s[20:23], s56 offen lds
  s_waitcnt vmcnt(14) lgkmcnt(0)
  v_mfma_f32_32x32x16_bf16 v[86:101], v[14:17], v[46:49], v[86:101]
  v_mfma_f32_32x32x16_bf16 v[102:117], v[14:17], v[50:53], v[102:117]
  v_mfma_f32_32x32x16_bf16 v[118:133], v[18:21], v[46:49], v[118:133]
  v_mfma_f32_32x32x16_bf16 v[134:149], v[18:21], v[50:53], v[134:149]
  s_add_u32 m0, s6, 6144
  s_add_u32 s56, s40, 8192
  buffer_load_dwordx4 v2, s[20:23], s40 offen lds
  s_add_u32 m0, s6, 7168
  s_add_u32 s40, s40, 16384
  buffer_load_dwordx4 v2, s[20:23], s56 offen lds
  s_setprio 2
  s_setprio 0
  s_mov_b32 s97, 0x40000
fg_own:
  s_sleep 2
  ds_read_b32 v151, v154 offset:4
  s_sub_u32 s97, s97, 1
  s_cbranch_scc1 fg_own_ok
  s_waitcnt lgkmcnt(0)
  v_readfirstlane_b32 s35, v151
  s_nop 1
  s_cmp_ge_u32 s35, 8
  s_cbranch_scc0 fg_own
fg_own_ok:
  s_waitcnt lgkmcnt(0)
  v_sub_f32 v152, 1.0, v152
  v_sub_f32 v153, 1.0, v153
  v_mov_b32 v6, v152
  v_mov_b32 v7, v152
  v_mov_b32 v8, v153
  v_mov_b32 v9, v153
  s_nop 7
  v_pk_mul_f32 v[86:87], v[86:87], v[6:7]
  v_pk_mul_f32 v[88:89], v[88:89], v[6:7]
  v_pk_mul_f32 v[90:91], v[90:91], v[6:7]
  v_pk_mul_f32 v[92:93], v[92:93], v[6:7]
  v_pk_mul_f32 v[94:95], v[94:95], v[6:7]
  v_pk_mul_f32 v[96:97], v[96:97], v[6:7]
  v_pk_mul_f32 v[98:99], v[98:99], v[6:7]
  v_pk_mul_f32 v[100:101], v[100:101], v[6:7]
  v_pk_mul_f32 v[102:103], v[102:103], v[8:9]
  v_pk_mul_f32 v[104:105], v[104:105], v[8:9]
  v_pk_mul_f32 v[106:107], v[106:107], v[8:9]
  v_pk_mul_f32 v[108:109], v[108:109], v[8:9]
  v_pk_mul_f32 v[110:111], v[110:111], v[8:9]
  v_pk_mul_f32 v[112:113], v[112:113], v[8:9]
  v_pk_mul_f32 v[114:115], v[114:115], v[8:9]
  v_pk_mul_f32 v[116:117], v[116:117], v[8:9]
  v_pk_mul_f32 v[118:119], v[118:119], v[6:7]
  v_pk_mul_f32 v[120:121], v[120:121], v[6:7]
  v_pk_mul_f32 v[122:123], v[122:123], v[6:7]
  v_pk_mul_f32 v[124:125], v[124:125], v[6:7]
  v_pk_mul_f32 v[126:127], v[126:127], v[6:7]
  v_pk_mul_f32 v[128:129], v[128:129], v[6:7]
  v_pk_mul_f32 v[130:131], v[130:131], v[6:7]
  v_pk_mul_f32 v[132:133], v[132:133], v[6:7]
  v_pk_mul_f32 v[134:135], v[134:135], v[8:9]
  v_pk_mul_f32 v[136:137], v[136:137], v[8:9]
  v_pk_mul_f32 v[138:139], v[138:139], v[8:9]
  v_pk_mul_f32 v[140:141], v[140:141], v[8:9]
  v_pk_mul_f32 v[142:143], v[142:143], v[8:9]
  v_pk_mul_f32 v[144:145], v[144:145], v[8:9]
  v_pk_mul_f32 v[146:147], v[146:147], v[8:9]
  v_pk_mul_f32 v[148:149], v[148:149], v[8:9]
  s_cmp_lg_u32 s3, 0
  s_cbranch_scc1 fg_nb0
  v_lshlrev_b32 v151, 16, v156
  v_fmac_f32 v86, v151, v152
  v_and_b32 v151, 0xffff0000, v156
  v_fmac_f32 v87, v151, v152
  v_lshlrev_b32 v151, 16, v157
  v_fmac_f32 v88, v151, v152
  v_and_b32 v151, 0xffff0000, v157
  v_fmac_f32 v89, v151, v152
  v_lshlrev_b32 v151, 16, v158
  v_fmac_f32 v90, v151, v152
  v_and_b32 v151, 0xffff0000, v158
  v_fmac_f32 v91, v151, v152
  v_lshlrev_b32 v151, 16, v159
  v_fmac_f32 v92, v151, v152
  v_and_b32 v151, 0xffff0000, v159
  v_fmac_f32 v93, v151, v152
  v_lshlrev_b32 v151, 16, v160
  v_fmac_f32 v94, v151, v152
  v_and_b32 v151, 0xffff0000, v160
  v_fmac_f32 v95, v151, v152
  v_lshlrev_b32 v151, 16, v161
  v_fmac_f32 v96, v151, v152
  v_and_b32 v151, 0xffff0000, v161
  v_fmac_f32 v97, v151, v152
  v_lshlrev_b32 v151, 16, v162
  v_fmac_f32 v98, v151, v152
  v_and_b32 v151, 0xffff0000, v162
  v_fmac_f32 v99, v151, v152
  v_lshlrev_b32 v151, 16, v163
  v_fmac_f32 v100, v151, v152
  v_and_b32 v151, 0xffff0000, v163
  v_fmac_f32 v101, v151, v152
fg_nb0:
  s_cmp_lg_u32 s3, 1
  s_cbranch_scc1 fg_nb1
  v_lshlrev_b32 v151, 16, v156
  v_fmac_f32 v102, v151, v153
  v_and_b32 v151, 0xffff0000, v156
  v_fmac_f32 v103, v151, v153
  v_lshlrev_b32 v151, 16, v157
  v_fmac_f32 v104, v151, v153
  v_and_b32 v151, 0xffff0000, v157
  v_fmac_f32 v105, v151, v153
  v_lshlrev_b32 v151, 16, v158
  v_fmac_f32 v106, v151, v153
  v_and_b32 v151, 0xffff0000, v158
  v_fmac_f32 v107, v151, v153
  v_lshlrev_b32 v151, 16, v159
  v_fmac_f32 v108, v151, v153
  v_and_b32 v151, 0xffff0000, v159
  v_fmac_f32 v109, v151, v153
  v_lshlrev_b32 v151, 16, v160
  v_fmac_f32 v110, v151, v153
  v_and_b32 v151, 0xffff0000, v160
  v_fmac_f32 v111, v151, v153
  v_lshlrev_b32 v151, 16, v161
  v_fmac_f32 v112, v151, v153
  v_and_b32 v151, 0xffff0000, v161
  v_fmac_f32 v113, v151, v153
  v_lshlrev_b32 v151, 16, v162
  v_fmac_f32 v114, v151, v153
  v_and_b32 v151, 0xffff0000, v162
  v_fmac_f32 v115, v151, v153
  v_lshlrev_b32 v151, 16, v163
  v_fmac_f32 v116, v151, v153
  v_and_b32 v151, 0xffff0000, v163
  v_fmac_f32 v117, v151, v153
fg_nb1:
  s_cmp_lg_u32 s3, 2
  s_cbranch_scc1 fg_nb2
  v_lshlrev_b32 v151, 16, v156
  v_fmac_f32 v118, v151, v152
  v_and_b32 v151, 0xffff0000, v156
  v_fmac_f32 v119, v151, v152
  v_lshlrev_b32 v151, 16, v157
  v_fmac_f32 v120, v151, v152
  v_and_b32 v151, 0xffff0000, v157
  v_fmac_f32 v121, v151, v152
  v_lshlrev_b32 v151, 16, v158
  v_fmac_f32 v122, v151, v152
  v_and_b32 v151, 0xffff0000, v158
  v_fmac_f32 v123, v151, v152
  v_lshlrev_b32 v151, 16, v159
  v_fmac_f32 v124, v151, v152
  v_and_b32 v151, 0xffff0000, v159
  v_fmac_f32 v125, v151, v152
  v_lshlrev_b32 v151, 16, v160
  v_fmac_f32 v126, v151, v152
  v_and_b32 v151, 0xffff0000, v160
  v_fmac_f32 v127, v151, v152
  v_lshlrev_b32 v151, 16, v161
  v_fmac_f32 v128, v151, v152
  v_and_b32 v151, 0xffff0000, v161
  v_fmac_f32 v129, v151, v152
  v_lshlrev_b32 v151, 16, v162
  v_fmac_f32 v130, v151, v152
  v_and_b32 v151, 0xffff0000, v162
  v_fmac_f32 v131, v151, v152
  v_lshlrev_b32 v151, 16, v163
  v_fmac_f32 v132, v151, v152
  v_and_b32 v151, 0xffff0000, v163
  v_fmac_f32 v133, v151, v152
fg_nb2:
  s_cmp_lg_u32 s3, 3
  s_cbranch_scc1 fg_nb3
  v_lshlrev_b32 v151, 16, v156
  v_fmac_f32 v134, v151, v153
  v_and_b32 v151, 0xffff0000, v156
  v_fmac_f32 v135, v151, v153
  v_lshlrev_b32 v151, 16, v157
  v_fmac_f32 v136, v151, v153
  v_and_b32 v151, 0xffff0000, v157
  v_fmac_f32 v137, v151, v153
  v_lshlrev_b32 v151, 16, v158
  v_fmac_f32 v138, v151, v153
  v_and_b32 v151, 0xffff0000, v158
  v_fmac_f32 v139, v151, v153
  v_lshlrev_b32 v151, 16, v159
  v_fmac_f32 v140, v151, v153
  v_and_b32 v151, 0xffff0000, v159
  v_fmac_f32 v141, v151, v153
  v_lshlrev_b32 v151, 16, v160
  v_fmac_f32 v142, v151, v153
  v_and_b32 v151, 0xffff0000, v160
  v_fmac_f32 v143, v151, v153
  v_lshlrev_b32 v151, 16, v161
  v_fmac_f32 v144, v151, v153
  v_and_b32 v151, 0xffff0000, v161
  v_fmac_f32 v145, v151, v153
  v_lshlrev_b32 v151, 16, v162
  v_fmac_f32 v146, v151, v153
  v_and_b32 v151, 0xffff0000, v162
  v_fmac_f32 v147, v151, v153
  v_lshlrev_b32 v151, 16, v163
  v_fmac_f32 v148, v151, v153
  v_and_b32 v151, 0xffff0000, v163
  v_fmac_f32 v149, v151, v153
fg_nb3:
  v_add_u32 v156, s6, v5
  s_add_u32 s34, s3, 1
  s_and_b32 s34, s34, 3
  s_lshl_b32 s34, s34, 2
  s_add_u32 s34, s34, s3
  s_lshl_b32 s34, s34, 12
  s_add_u32 s34, s34, 73728
  v_add_u32 v157, s34, v5
  s_add_u32 s34, s3, 2
  s_and_b32 s34, s34, 3
  s_lshl_b32 s34, s34, 2
  s_add_u32 s34, s34, s3
  s_lshl_b32 s34, s34, 12
  s_add_u32 s34, s34, 73728
  v_add_u32 v158, s34, v5
  s_add_u32 s34, s3, 3
  s_and_b32 s34, s34, 3
  s_lshl_b32 s34, s34, 2
  s_add_u32 s34, s34, s3
  s_lshl_b32 s34, s34, 12
  s_add_u32 s34, s34, 73728
  v_add_u32 v159, s34, v5
  v_and_b32 v160, 31, v0
  v_lshlrev_b32 v160, 10, v160
  v_lshrrev_b32 v151, 5, v0
  v_lshl_add_u32 v160, v151, 4, v160
  s_lshl_b32 s46, s7, 16
  s_and_b32 s35, s3, 1
  s_lshl_b32 s35, s35, 15
  s_add_u32 s46, s46, s35
  s_add_u32 s46, s46, s33
  s_lshr_b32 s35, s3, 1
  s_lshl_b32 s35, s35, 6
  s_add_u32 s46, s46, s35
  s_lshr_b32 s59, s7, 2
  s_lshl_b32 s59, s59, 8
  s_add_u32 s59, s59, 17899520
  s_setprio 0
  s_mov_b32 s42, s41
  s_setprio 2
  s_mov_b32 s43, 0x10000
  s_waitcnt vmcnt(0)
  ds_read_b64_tr_b16 v[6:7], v3 offset:8192
  ds_read_b64_tr_b16 v[8:9], v3 offset:8704
  ds_read_b64_tr_b16 v[10:11], v4 offset:8192
  ds_read_b64_tr_b16 v[12:13], v4 offset:8704
  s_mov_b64 exec, 0xffff
fg_op0:
  v_cmp_eq_u32 vcc, -1, v165
  s_sub_u32 s43, s43, 1
  s_cselect_b32 s45, 1, 0
  s_cselect_b32 s43, 0, s43
  s_cmp_lg_u32 s45, 0
  s_cbranch_scc1 fg_og0
  s_cbranch_vccz fg_og0
  buffer_load_dword v165, v164, s[12:15], s42 offen sc1
  s_waitcnt vmcnt(0)
  s_branch fg_op0
fg_og0:
  s_mov_b64 exec, -1
  s_add_u32 s56, s42, 0
  s_add_u32 s44, s42, 32768
  buffer_load_dwordx4 v[22:25], v5, s[12:15], s56 offen sc1
  buffer_load_dwordx4 v[26:29], v5, s[12:15], s44 offen sc1
  s_add_u32 s56, s42, 1024
  s_add_u32 s44, s42, 33792
  buffer_load_dwordx4 v[30:33], v5, s[12:15], s56 offen sc1
  buffer_load_dwordx4 v[34:37], v5, s[12:15], s44 offen sc1
  s_add_u32 s56, s42, 2048
  s_add_u32 s44, s42, 34816
  buffer_load_dwordx4 v[38:41], v5, s[12:15], s56 offen sc1
  buffer_load_dwordx4 v[42:45], v5, s[12:15], s44 offen sc1
  s_add_u32 s56, s42, 3072
  s_add_u32 s44, s42, 35840
  buffer_load_dwordx4 v[46:49], v5, s[12:15], s56 offen sc1
  buffer_load_dwordx4 v[50:53], v5, s[12:15], s44 offen sc1
  s_add_u32 s56, s42, 4096
  s_add_u32 s44, s42, 36864
  buffer_load_dwordx4 v[54:57], v5, s[12:15], s56 offen sc1
  buffer_load_dwordx4 v[58:61], v5, s[12:15], s44 offen sc1
  s_add_u32 s56, s42, 5120
  s_add_u32 s44, s42, 37888
  buffer_load_dwordx4 v[62:65], v5, s[12:15], s56 offen sc1
  buffer_load_dwordx4 v[66:69], v5, s[12:15], s44 offen sc1
  s_add_u32 s56, s42, 6144
  s_add_u32 s44, s42, 38912
  buffer_load_dwordx4 v[70:73], v5, s[12:15], s56 offen sc1
  buffer_load_dwordx4 v[74:77], v5, s[12:15], s44 offen sc1
  s_add_u32 s56, s42, 7168
  s_add_u32 s44, s42, 39936
  buffer_load_dwordx4 v[78:81], v5, s[12:15], s56 offen sc1
  buffer_load_dwordx4 v[82:85], v5, s[12:15], s44 offen sc1
fg_os0:
  s_waitcnt vmcnt(14) lgkmcnt(0)
  v_max3_u32 v151, v22, v23, v24
  v_max3_u32 v151, v151, v25, v26
  v_max3_u32 v151, v151, v27, v28
  v_max_u32 v151, v151, v29
  v_cmp_eq_u32 vcc, -1, v151
  s_cmp_eq_u32 s43, 0
  s_cbranch_scc1 fg_om0
  s_cbranch_vccnz fg_or0
fg_om0:
  ds_read_b64_tr_b16 v[14:15], v3 offset:10240
  ds_read_b64_tr_b16 v[16:17], v3 offset:10752
  ds_read_b64_tr_b16 v[18:19], v4 offset:10240
  ds_read_b64_tr_b16 v[20:21], v4 offset:10752
  v_mfma_f32_32x32x16_bf16 v[86:101], v[6:9], v[22:25], v[86:101]
  v_mfma_f32_32x32x16_bf16 v[102:117], v[6:9], v[26:29], v[102:117]
  v_mfma_f32_32x32x16_bf16 v[118:133], v[10:13], v[22:25], v[118:133]
  v_mfma_f32_32x32x16_bf16 v[134:149], v[10:13], v[26:29], v[134:149]
fg_os1:
  s_waitcnt vmcnt(12) lgkmcnt(0)
  v_max3_u32 v151, v30, v31, v32
  v_max3_u32 v151, v151, v33, v34
  v_max3_u32 v151, v151, v35, v36
  v_max_u32 v151, v151, v37
  v_cmp_eq_u32 vcc, -1, v151
  s_cmp_eq_u32 s43, 0
  s_cbranch_scc1 fg_om1
  s_cbranch_vccnz fg_or1
fg_om1:
  ds_read_b64_tr_b16 v[6:7], v3 offset:12288
  ds_read_b64_tr_b16 v[8:9], v3 offset:12800
  ds_read_b64_tr_b16 v[10:11], v4 offset:12288
  ds_read_b64_tr_b16 v[12:13], v4 offset:12800
  v_mfma_f32_32x32x16_bf16 v[86:101], v[14:17], v[30:33], v[86:101]
  v_mfma_f32_32x32x16_bf16 v[102:117], v[14:17], v[34:37], v[102:117]
  v_mfma_f32_32x32x16_bf16 v[118:133], v[18:21], v[30:33], v[118:133]
  v_mfma_f32_32x32x16_bf16 v[134:149], v[18:21], v[34:37], v[134:149]
fg_os2:
  s_waitcnt vmcnt(10) lgkmcnt(0)
  v_max3_u32 v151, v38, v39, v40
  v_max3_u32 v151, v151, v41, v42
  v_max3_u32 v151, v151, v43, v44
  v_max_u32 v151, v151, v45
  v_cmp_eq_u32 vcc, -1, v151
  s_cmp_eq_u32 s43, 0
  s_cbranch_scc1 fg_om2
  s_cbranch_vccnz fg_or2
fg_om2:
  ds_read_b64_tr_b16 v[14:15], v3 offset:14336
  ds_read_b64_tr_b16 v[16:17], v3 offset:14848
  ds_read_b64_tr_b16 v[18:19], v4 offset:14336
  ds_read_b64_tr_b16 v[20:21], v4 offset:14848
  v_mfma_f32_32x32x16_bf16 v[86:101], v[6:9], v[38:41], v[86:101]
  v_mfma_f32_32x32x16_bf16 v[102:117], v[6:9], v[42:45], v[102:117]
  v_mfma_f32_32x32x16_bf16 v[118:133], v[10:13], v[38:41], v[118:133]
  v_mfma_f32_32x32x16_bf16 v[134:149], v[10:13], v[42:45], v[134:149]
fg_os3:
  s_waitcnt vmcnt(8) lgkmcnt(0)
  v_max3_u32 v151, v46, v47, v48
  v_max3_u32 v151, v151, v49, v50
  v_max3_u32 v151, v151, v51, v52
  v_max_u32 v151, v151, v53
  v_cmp_eq_u32 vcc, -1, v151
  s_cmp_eq_u32 s43, 0
  s_cbranch_scc1 fg_om3
  s_cbranch_vccnz fg_or3
fg_om3:
  ds_read_b64_tr_b16 v[6:7], v3 offset:0
  ds_read_b64_tr_b16 v[8:9], v3 offset:512
  ds_read_b64_tr_b16 v[10:11], v4 offset:0
  ds_read_b64_tr_b16 v[12:13], v4 offset:512
  v_mfma_f32_32x32x16_bf16 v[86:101], v[14:17], v[46:49], v[86:101]
  v_mfma_f32_32x32x16_bf16 v[102:117], v[14:17], v[50:53], v[102:117]
  v_mfma_f32_32x32x16_bf16 v[118:133], v[18:21], v[46:49], v[118:133]
  v_mfma_f32_32x32x16_bf16 v[134:149], v[18:21], v[50:53], v[134:149]
fg_os4:
  s_waitcnt vmcnt(6) lgkmcnt(0)
  v_max3_u32 v151, v54, v55, v56
  v_max3_u32 v151, v151, v57, v58
  v_max3_u32 v151, v151, v59, v60
  v_max_u32 v151, v151, v61
  v_cmp_eq_u32 vcc, -1, v151
  s_cmp_eq_u32 s43, 0
  s_cbranch_scc1 fg_om4
  s_cbranch_vccnz fg_or4
fg_om4:
  ds_read_b64_tr_b16 v[14:15], v3 offset:2048
  ds_read_b64_tr_b16 v[16:17], v3 offset:2560
  ds_read_b64_tr_b16 v[18:19], v4 offset:2048
  ds_read_b64_tr_b16 v[20:21], v4 offset:2560
  v_mfma_f32_32x32x16_bf16 v[86:101], v[6:9], v[54:57], v[86:101]
  v_mfma_f32_32x32x16_bf16 v[102:117], v[6:9], v[58:61], v[102:117]
  v_mfma_f32_32x32x16_bf16 v[118:133], v[10:13], v[54:57], v[118:133]
  v_mfma_f32_32x32x16_bf16 v[134:149], v[10:13], v[58:61], v[134:149]
fg_os5:
  s_waitcnt vmcnt(4) lgkmcnt(0)
  v_max3_u32 v151, v62, v63, v64
  v_max3_u32 v151, v151, v65, v66
  v_max3_u32 v151, v151, v67, v68
  v_max_u32 v151, v151, v69
  v_cmp_eq_u32 vcc, -1, v151
  s_cmp_eq_u32 s43, 0
  s_cbranch_scc1 fg_om5
  s_cbranch_vccnz fg_or5
fg_om5:
  ds_read_b64_tr_b16 v[6:7], v3 offset:4096
  ds_read_b64_tr_b16 v[8:9], v3 offset:4608
  ds_read_b64_tr_b16 v[10:11], v4 offset:4096
  ds_read_b64_tr_b16 v[12:13], v4 offset:4608
  v_mfma_f32_32x32x16_bf16 v[86:101], v[14:17], v[62:65], v[86:101]
  v_mfma_f32_32x32x16_bf16 v[102:117], v[14:17], v[66:69], v[102:117]
  v_mfma_f32_32x32x16_bf16 v[118:133], v[18:21], v[62:65], v[118:133]
  v_mfma_f32_32x32x16_bf16 v[134:149], v[18:21], v[66:69], v[134:149]
fg_os6:
  s_waitcnt vmcnt(2) lgkmcnt(0)
  v_max3_u32 v151, v70, v71, v72
  v_max3_u32 v151, v151, v73, v74
  v_max3_u32 v151, v151, v75, v76
  v_max_u32 v151, v151, v77
  v_cmp_eq_u32 vcc, -1, v151
  s_cmp_eq_u32 s43, 0
  s_cbranch_scc1 fg_om6
  s_cbranch_vccnz fg_or6
fg_om6:
  ds_read_b64_tr_b16 v[14:15], v3 offset:6144
  ds_read_b64_tr_b16 v[16:17], v3 offset:6656
  ds_read_b64_tr_b16 v[18:19], v4 offset:6144
  ds_read_b64_tr_b16 v[20:21], v4 offset:6656
  v_mfma_f32_32x32x16_bf16 v[86:101], v[6:9], v[70:73], v[86:101]
  v_mfma_f32_32x32x16_bf16 v[102:117], v[6:9], v[74:77], v[102:117]
  v_mfma_f32_32x32x16_bf16 v[118:133], v[10:13], v[70:73], v[118:133]
  v_mfma_f32_32x32x16_bf16 v[134:149], v[10:13], v[74:77], v[134:149]
fg_os7:
  s_waitcnt vmcnt(0) lgkmcnt(0)
  v_max3_u32 v151, v78, v79, v80
  v_max3_u32 v151, v151, v81, v82
  v_max3_u32 v151, v151, v83, v84
  v_max_u32 v151, v151, v85
  v_cmp_eq_u32 vcc, -1, v151
  s_cmp_eq_u32 s43, 0
  s_cbranch_scc1 fg_om7
  s_cbranch_vccnz fg_or7
fg_om7:
  v_mfma_f32_32x32x16_bf16 v[86:101], v[14:17], v[78:81], v[86:101]
  v_mfma_f32_32x32x16_bf16 v[102:117], v[14:17], v[82:85], v[102:117]
  v_mfma_f32_32x32x16_bf16 v[118:133], v[18:21], v[78:81], v[118:133]
  v_mfma_f32_32x32x16_bf16 v[134:149], v[18:21], v[82:85], v[134:149]
  s_branch fg_odone
fg_or0:
  s_mov_b64 exec, 0xffff
  s_add_u32 s44, s42, 0
fg_rp0:
  buffer_load_dword v151, v164, s[12:15], s44 offen sc1
  s_sub_u32 s43, s43, 1
  s_cselect_b32 s45, 1, 0
  s_cselect_b32 s43, 0, s43
  s_waitcnt vmcnt(0)
  v_cmp_eq_u32 vcc, -1, v151
  s_cmp_lg_u32 s45, 0
  s_cbranch_scc1 fg_rg0
  s_cbranch_vccnz fg_rp0
fg_rg0:
  s_mov_b64 exec, -1
  s_add_u32 s56, s42, 0
  s_add_u32 s44, s42, 32768
  buffer_load_dwordx4 v[22:25], v5, s[12:15], s56 offen sc1
  buffer_load_dwordx4 v[26:29], v5, s[12:15], s44 offen sc1
  s_add_u32 s56, s42, 1024
  s_add_u32 s44, s42, 33792
  buffer_load_dwordx4 v[30:33], v5, s[12:15], s56 offen sc1
  buffer_load_dwordx4 v[34:37], v5, s[12:15], s44 offen sc1
  s_add_u32 s56, s42, 2048
  s_add_u32 s44, s42, 34816
  buffer_load_dwordx4 v[38:41], v5, s[12:15], s56 offen sc1
  buffer_load_dwordx4 v[42:45], v5, s[12:15], s44 offen sc1
  s_add_u32 s56, s42, 3072
  s_add_u32 s44, s42, 35840
  buffer_load_dwordx4 v[46:49], v5, s[12:15], s56 offen sc1
  buffer_load_dwordx4 v[50:53], v5, s[12:15], s44 offen sc1
  s_add_u32 s56, s42, 4096
  s_add_u32 s44, s42, 36864
  buffer_load_dwordx4 v[54:57], v5, s[12:15], s56 offen sc1
  buffer_load_dwordx4 v[58:61], v5, s[12:15], s44 offen sc1
  s_add_u32 s56, s42, 5120
  s_add_u32 s44, s42, 37888
  buffer_load_dwordx4 v[62:65], v5, s[12:15], s56 offen sc1
  buffer_load_dwordx4 v[66:69], v5, s[12:15], s44 offen sc1
  s_add_u32 s56, s42, 6144
  s_add_u32 s44, s42, 38912
  buffer_load_dwordx4 v[70:73], v5, s[12:15], s56 offen sc1
  buffer_load_dwordx4 v[74:77], v5, s[12:15], s44 offen sc1
  s_add_u32 s56, s42, 7168
  s_add_u32 s44, s42, 39936
  buffer_load_dwordx4 v[78:81], v5, s[12:15], s56 offen sc1
  buffer_load_dwordx4 v[82:85], v5, s[12:15], s44 offen sc1
  s_branch fg_os0
fg_or1:
  s_mov_b64 exec, 0x3fff
  s_add_u32 s44, s42, 1024
fg_rp1:
  buffer_load_dword v151, v164, s[12:15], s44 offen sc1
  s_sub_u32 s43, s43, 1
  s_cselect_b32 s45, 1, 0
  s_cselect_b32 s43, 0, s43
  s_waitcnt vmcnt(0)
  v_cmp_eq_u32 vcc, -1, v151
  s_cmp_lg_u32 s45, 0
  s_cbranch_scc1 fg_rg1
  s_cbranch_vccnz fg_rp1
fg_rg1:
  s_mov_b64 exec, -1
  s_add_u32 s56, s42, 1024
  s_add_u32 s44, s42, 33792
  buffer_load_dwordx4 v[30:33], v5, s[12:15], s56 offen sc1
  buffer_load_dwordx4 v[34:37], v5, s[12:15], s44 offen sc1
  s_add_u32 s56, s42, 2048
  s_add_u32 s44, s42, 34816
  buffer_load_dwordx4 v[38:41], v5, s[12:15], s56 offen sc1
  buffer_load_dwordx4 v[42:45], v5, s[12:15], s44 offen sc1
  s_add_u32 s56, s42, 3072
  s_add_u32 s44, s42, 35840
  buffer_load_dwordx4 v[46:49], v5, s[12:15], s56 offen sc1
  buffer_load_dwordx4 v[50:53], v5, s[12:15], s44 offen sc1
  s_add_u32 s56, s42, 4096
  s_add_u32 s44, s42, 36864
  buffer_load_dwordx4 v[54:57], v5, s[12:15], s56 offen sc1
  buffer_load_dwordx4 v[58:61], v5, s[12:15], s44 offen sc1
  s_add_u32 s56, s42, 5120
  s_add_u32 s44, s42, 37888
  buffer_load_dwordx4 v[62:65], v5, s[12:15], s56 offen sc1
  buffer_load_dwordx4 v[66:69], v5, s[12:15], s44 offen sc1
  s_add_u32 s56, s42, 6144
  s_add_u32 s44, s42, 38912
  buffer_load_dwordx4 v[70:73], v5, s[12:15], s56 offen sc1
  buffer_load_dwordx4 v[74:77], v5, s[12:15], s44 offen sc1
  s_add_u32 s56, s42, 7168
  s_add_u32 s44, s42, 39936
  buffer_load_dwordx4 v[78:81], v5, s[12:15], s56 offen sc1
  buffer_load_dwordx4 v[82:85], v5, s[12:15], s44 offen sc1
  s_branch fg_os1
fg_or2:
  s_mov_b64 exec, 0xfff
  s_add_u32 s44, s42, 2048
fg_rp2:
  buffer_load_dword v151, v164, s[12:15], s44 offen sc1
  s_sub_u32 s43, s43, 1
  s_cselect_b32 s45, 1, 0
  s_cselect_b32 s43, 0, s43
  s_waitcnt vmcnt(0)
  v_cmp_eq_u32 vcc, -1, v151
  s_cmp_lg_u32 s45, 0
  s_cbranch_scc1 fg_rg2
  s_cbranch_vccnz fg_rp2
fg_rg2:
  s_mov_b64 exec, -1
  s_add_u32 s56, s42, 2048
  s_add_u32 s44, s42, 34816
  buffer_load_dwordx4 v[38:41], v5, s[12:15], s56 offen sc1
  buffer_load_dwordx4 v[42:45], v5, s[12:15], s44 offen sc1
  s_add_u32 s56, s42, 3072
  s_add_u32 s44, s42, 35840
  buffer_load_dwordx4 v[46:49], v5, s[12:15], s56 offen sc1
  buffer_load_dwordx4 v[50:53], v5, s[12:15], s44 offen sc1
  s_add_u32 s56, s42, 4096
  s_add_u32 s44, s42, 36864
  buffer_load_dwordx4 v[54:57], v5, s[12:15], s56 offen sc1
  buffer_load_dwordx4 v[58:61], v5, s[12:15], s44 offen sc1
  s_add_u32 s56, s42, 5120
  s_add_u32 s44, s42, 37888
  buffer_load_dwordx4 v[62:65], v5, s[12:15], s56 offen sc1
  buffer_load_dwordx4 v[66:69], v5, s[12:15], s44 offen sc1
  s_add_u32 s56, s42, 6144
  s_add_u32 s44, s42, 38912
  buffer_load_dwordx4 v[70:73], v5, s[12:15], s56 offen sc1
  buffer_load_dwordx4 v[74:77], v5, s[12:15], s44 offen sc1
  s_add_u32 s56, s42, 7168
  s_add_u32 s44, s42, 39936
  buffer_load_dwordx4 v[78:81], v5, s[12:15], s56 offen sc1
  buffer_load_dwordx4 v[82:85], v5, s[12:15], s44 offen sc1
  s_branch fg_os2
fg_or3:
  s_mov_b64 exec, 0x3ff
  s_add_u32 s44, s42, 3072
fg_rp3:
  buffer_load_dword v151, v164, s[12:15], s44 offen sc1
  s_sub_u32 s43, s43, 1
  s_cselect_b32 s45, 1, 0
  s_cselect_b32 s43, 0, s43
  s_waitcnt vmcnt(0)
  v_cmp_eq_u32 vcc, -1, v151
  s_cmp_lg_u32 s45, 0
  s_cbranch_scc1 fg_rg3
  s_cbranch_vccnz fg_rp3
fg_rg3:
  s_mov_b64 exec, -1
  s_add_u32 s56, s42, 3072
  s_add_u32 s44, s42, 35840
  buffer_load_dwordx4 v[46:49], v5, s[12:15], s56 offen sc1
  buffer_load_dwordx4 v[50:53], v5, s[12:15], s44 offen sc1
  s_add_u32 s56, s42, 4096
  s_add_u32 s44, s42, 36864
  buffer_load_dwordx4 v[54:57], v5, s[12:15], s56 offen sc1
  buffer_load_dwordx4 v[58:61], v5, s[12:15], s44 offen sc1
  s_add_u32 s56, s42, 5120
  s_add_u32 s44, s42, 37888
  buffer_load_dwordx4 v[62:65], v5, s[12:15], s56 offen sc1
  buffer_load_dwordx4 v[66:69], v5, s[12:15], s44 offen sc1
  s_add_u32 s56, s42, 6144
  s_add_u32 s44, s42, 38912
  buffer_load_dwordx4 v[70:73], v5, s[12:15], s56 offen sc1
  buffer_load_dwordx4 v[74:77], v5, s[12:15], s44 offen sc1
  s_add_u32 s56, s42, 7168
  s_add_u32 s44, s42, 39936
  buffer_load_dwordx4 v[78:81], v5, s[12:15], s56 offen sc1
  buffer_load_dwordx4 v[82:85], v5, s[12:15], s44 offen sc1
  s_branch fg_os3
fg_or4:
  s_mov_b64 exec, 0xff
  s_add_u32 s44, s42, 4096
fg_rp4:
  buffer_load_dword v151, v164, s[12:15], s44 offen sc1
  s_sub_u32 s43, s43, 1
  s_cselect_b32 s45, 1, 0
  s_cselect_b32 s43, 0, s43
  s_waitcnt vmcnt(0)
  v_cmp_eq_u32 vcc, -1, v151
  s_cmp_lg_u32 s45, 0
  s_cbranch_scc1 fg_rg4
  s_cbranch_vccnz fg_rp4
fg_rg4:
  s_mov_b64 exec, -1
  s_add_u32 s56, s42, 4096
  s_add_u32 s44, s42, 36864
  buffer_load_dwordx4 v[54:57], v5, s[12:15], s56 offen sc1
  buffer_load_dwordx4 v[58:61], v5, s[12:15], s44 offen sc1
  s_add_u32 s56, s42, 5120
  s_add_u32 s44, s42, 37888
  buffer_load_dwordx4 v[62:65], v5, s[12:15], s56 offen sc1
  buffer_load_dwordx4 v[66:69], v5, s[12:15], s44 offen sc1
  s_add_u32 s56, s42, 6144
  s_add_u32 s44, s42, 38912
  buffer_load_dwordx4 v[70:73], v5, s[12:15], s56 offen sc1
  buffer_load_dwordx4 v[74:77], v5, s[12:15], s44 offen sc1
  s_add_u32 s56, s42, 7168
  s_add_u32 s44, s42, 39936
  buffer_load_dwordx4 v[78:81], v5, s[12:15], s56 offen sc1
  buffer_load_dwordx4 v[82:85], v5, s[12:15], s44 offen sc1
  s_branch fg_os4
fg_or5:
  s_mov_b64 exec, 0x3f
  s_add_u32 s44, s42, 5120
fg_rp5:
  buffer_load_dword v151, v164, s[12:15], s44 offen sc1
  s_sub_u32 s43, s43, 1
  s_cselect_b32 s45, 1, 0
  s_cselect_b32 s43, 0, s43
  s_waitcnt vmcnt(0)
  v_cmp_eq_u32 vcc, -1, v151
  s_cmp_lg_u32 s45, 0
  s_cbranch_scc1 fg_rg5
  s_cbranch_vccnz fg_rp5
fg_rg5:
  s_mov_b64 exec, -1
  s_add_u32 s56, s42, 5120
  s_add_u32 s44, s42, 37888
  buffer_load_dwordx4 v[62:65], v5, s[12:15], s56 offen sc1
  buffer_load_dwordx4 v[66:69], v5, s[12:15], s44 offen sc1
  s_add_u32 s56, s42, 6144
  s_add_u32 s44, s42, 38912
  buffer_load_dwordx4 v[70:73], v5, s[12:15], s56 offen sc1
  buffer_load_dwordx4 v[74:77], v5, s[12:15], s44 offen sc1
  s_add_u32 s56, s42, 7168
  s_add_u32 s44, s42, 39936
  buffer_load_dwordx4 v[78:81], v5, s[12:15], s56 offen sc1
  buffer_load_dwordx4 v[82:85], v5, s[12:15], s44 offen sc1
  s_branch fg_os5
fg_or6:
  s_mov_b64 exec, 0xf
  s_add_u32 s44, s42, 6144
fg_rp6:
  buffer_load_dword v151, v164, s[12:15], s44 offen sc1
  s_sub_u32 s43, s43, 1
  s_cselect_b32 s45, 1, 0
  s_cselect_b32 s43, 0, s43
  s_waitcnt vmcnt(0)
  v_cmp_eq_u32 vcc, -1, v151
  s_cmp_lg_u32 s45, 0
  s_cbranch_scc1 fg_rg6
  s_cbranch_vccnz fg_rp6
fg_rg6:
  s_mov_b64 exec, -1
  s_add_u32 s56, s42, 6144
  s_add_u32 s44, s42, 38912
  buffer_load_dwordx4 v[70:73], v5, s[12:15], s56 offen sc1
  buffer_load_dwordx4 v[74:77], v5, s[12:15], s44 offen sc1
  s_add_u32 s56, s42, 7168
  s_add_u32 s44, s42, 39936
  buffer_load_dwordx4 v[78:81], v5, s[12:15], s56 offen sc1
  buffer_load_dwordx4 v[82:85], v5, s[12:15], s44 offen sc1
  s_branch fg_os6
fg_or7:
  s_mov_b64 exec, 0x3
  s_add_u32 s44, s42, 7168
fg_rp7:
  buffer_load_dword v151, v164, s[12:15], s44 offen sc1
  s_sub_u32 s43, s43, 1
  s_cselect_b32 s45, 1, 0
  s_cselect_b32 s43, 0, s43
  s_waitcnt vmcnt(0)
  v_cmp_eq_u32 vcc, -1, v151
  s_cmp_lg_u32 s45, 0
  s_cbranch_scc1 fg_rg7
  s_cbranch_vccnz fg_rp7
fg_rg7:
  s_mov_b64 exec, -1
  s_add_u32 s56, s42, 7168
  s_add_u32 s44, s42, 39936
  buffer_load_dwordx4 v[78:81], v5, s[12:15], s56 offen sc1
  buffer_load_dwordx4 v[82:85], v5, s[12:15], s44 offen sc1
  s_branch fg_os7
fg_odone:
  s_nop 7
  s_nop 1
  s_cmp_eq_u32 s3, 0
  s_cbranch_scc1 fg_skip0
  ds_write_b128 v156, v[86:89] offset:0
  ds_write_b128 v156, v[90:93] offset:1024
  ds_write_b128 v156, v[94:97] offset:2048
  ds_write_b128 v156, v[98:101] offset:3072
fg_skip0:
  s_cmp_eq_u32 s3, 1
  s_cbranch_scc1 fg_skip1
  ds_write_b128 v156, v[102:105] offset:4096
  ds_write_b128 v156, v[106:109] offset:5120
  ds_write_b128 v156, v[110:113] offset:6144
  ds_write_b128 v156, v[114:117] offset:7168
fg_skip1:
  s_cmp_eq_u32 s3, 2
  s_cbranch_scc1 fg_skip2
  ds_write_b128 v156, v[118:121] offset:8192
  ds_write_b128 v156, v[122:125] offset:9216
  ds_write_b128 v156, v[126:129] offset:10240
  ds_write_b128 v156, v[130:133] offset:11264
fg_skip2:
  s_cmp_eq_u32 s3, 3
  s_cbranch_scc1 fg_skip3
  ds_write_b128 v156, v[134:137] offset:12288
  ds_write_b128 v156, v[138:141] offset:13312
  ds_write_b128 v156, v[142:145] offset:14336
  ds_write_b128 v156, v[146:149] offset:15360
fg_skip3:
  s_waitcnt lgkmcnt(0)
  s_barrier
  s_cmp_lg_u32 s3, 0
  s_cbranch_scc1 fg_fin1
  ds_read_b128 v[102:105], v157 offset:0
  ds_read_b128 v[106:109], v157 offset:1024
  ds_read_b128 v[110:113], v157 offset:2048
  ds_read_b128 v[114:117], v157 offset:3072
  ds_read_b128 v[118:121], v158 offset:0
  ds_read_b128 v[122:125], v158 offset:1024
  ds_read_b128 v[126:129], v158 offset:2048
  ds_read_b128 v[130:133], v158 offset:3072
  ds_read_b128 v[134:137], v159 offset:0
  ds_read_b128 v[138:141], v159 offset:1024
  ds_read_b128 v[142:145], v159 offset:2048
  ds_read_b128 v[146:149], v159 offset:3072
  s_waitcnt lgkmcnt(8)
  v_pk_add_f32 v[86:87], v[86:87], v[102:103]
  v_pk_add_f32 v[88:89], v[88:89], v[104:105]
  v_pk_add_f32 v[90:91], v[90:91], v[106:107]
  v_pk_add_f32 v[92:93], v[92:93], v[108:109]
  v_pk_add_f32 v[94:95], v[94:95], v[110:111]
  v_pk_add_f32 v[96:97], v[96:97], v[112:113]
  v_pk_add_f32 v[98:99], v[98:99], v[114:115]
  v_pk_add_f32 v[100:101], v[100:101], v[116:117]
  s_waitcnt lgkmcnt(4)
  v_pk_add_f32 v[86:87], v[86:87], v[118:119]
  v_pk_add_f32 v[88:89], v[88:89], v[120:121]
  v_pk_add_f32 v[90:91], v[90:91], v[122:123]
  v_pk_add_f32 v[92:93], v[92:93], v[124:125]
  v_pk_add_f32 v[94:95], v[94:95], v[126:127]
  v_pk_add_f32 v[96:97], v[96:97], v[128:129]
  v_pk_add_f32 v[98:99], v[98:99], v[130:131]
  v_pk_add_f32 v[100:101], v[100:101], v[132:133]
  s_waitcnt lgkmcnt(0)
  v_pk_add_f32 v[86:87], v[86:87], v[134:135]
  v_pk_add_f32 v[88:89], v[88:89], v[136:137]
  v_pk_add_f32 v[90:91], v[90:91], v[138:139]
  v_pk_add_f32 v[92:93], v[92:93], v[140:141]
  v_pk_add_f32 v[94:95], v[94:95], v[142:143]
  v_pk_add_f32 v[96:97], v[96:97], v[144:145]
  v_pk_add_f32 v[98:99], v[98:99], v[146:147]
  v_pk_add_f32 v[100:101], v[100:101], v[148:149]
  v_cvt_pk_bf16_f32 v22, v86, v87
  v_cvt_pk_bf16_f32 v23, v88, v89
  v_cvt_pk_bf16_f32 v24, v90, v91
  v_cvt_pk_bf16_f32 v25, v92, v93
  buffer_store_dwordx4 v[22:25], v160, s[24:27], s46 offen offset:0
  v_cvt_pk_bf16_f32 v26, v94, v95
  v_cvt_pk_bf16_f32 v27, v96, v97
  v_cvt_pk_bf16_f32 v28, v98, v99
  v_cvt_pk_bf16_f32 v29, v100, v101
  buffer_store_dwordx4 v[26:29], v160, s[24:27], s46 offen offset:32
  s_branch fg_stored
fg_fin1:
  s_cmp_lg_u32 s3, 1
  s_cbranch_scc1 fg_fin2
  ds_read_b128 v[86:89], v157 offset:0
  ds_read_b128 v[90:93], v157 offset:1024
  ds_read_b128 v[94:97], v157 offset:2048
  ds_read_b128 v[98:101], v157 offset:3072
  ds_read_b128 v[118:121], v158 offset:0
  ds_read_b128 v[122:125], v158 offset:1024
  ds_read_b128 v[126:129], v158 offset:2048
  ds_read_b128 v[130:133], v158 offset:3072
  ds_read_b128 v[134:137], v159 offset:0
  ds_read_b128 v[138:141], v159 offset:1024
  ds_read_b128 v[142:145], v159 offset:2048
  ds_read_b128 v[146:149], v159 offset:3072
  s_waitcnt lgkmcnt(8)
  v_pk_add_f32 v[102:103], v[102:103], v[86:87]
  v_pk_add_f32 v[104:105], v[104:105], v[88:89]
  v_pk_add_f32 v[106:107], v[106:107], v[90:91]
  v_pk_add_f32 v[108:109], v[108:109], v[92:93]
  v_pk_add_f32 v[110:111], v[110:111], v[94:95]
  v_pk_add_f32 v[112:113], v[112:113], v[96:97]
  v_pk_add_f32 v[114:115], v[114:115], v[98:99]
  v_pk_add_f32 v[116:117], v[116:117], v[100:101]
  s_waitcnt lgkmcnt(4)
  v_pk_add_f32 v[102:103], v[102:103], v[118:119]
  v_pk_add_f32 v[104:105], v[104:105], v[120:121]
  v_pk_add_f32 v[106:107], v[106:107], v[122:123]
  v_pk_add_f32 v[108:109], v[108:109], v[124:125]
  v_pk_add_f32 v[110:111], v[110:111], v[126:127]
  v_pk_add_f32 v[112:113], v[112:113], v[128:129]
  v_pk_add_f32 v[114:115], v[114:115], v[130:131]
  v_pk_add_f32 v[116:117], v[116:117], v[132:133]
  s_waitcnt lgkmcnt(0)
  v_pk_add_f32 v[102:103], v[102:103], v[134:135]
  v_pk_add_f32 v[104:105], v[104:105], v[136:137]
  v_pk_add_f32 v[106:107], v[106:107], v[138:139]
  v_pk_add_f32 v[108:109], v[108:109], v[140:141]
  v_pk_add_f32 v[110:111], v[110:111], v[142:143]
  v_pk_add_f32 v[112:113], v[112:113], v[144:145]
  v_pk_add_f32 v[114:115], v[114:115], v[146:147]
  v_pk_add_f32 v[116:117], v[116:117], v[148:149]
  v_cvt_pk_bf16_f32 v22, v102, v103
  v_cvt_pk_bf16_f32 v23, v104, v105
  v_cvt_pk_bf16_f32 v24, v106, v107
  v_cvt_pk_bf16_f32 v25, v108, v109
  buffer_store_dwordx4 v[22:25], v160, s[24:27], s46 offen offset:0
  v_cvt_pk_bf16_f32 v26, v110, v111
  v_cvt_pk_bf16_f32 v27, v112, v113
  v_cvt_pk_bf16_f32 v28, v114, v115
  v_cvt_pk_bf16_f32 v29, v116, v117
  buffer_store_dwordx4 v[26:29], v160, s[24:27], s46 offen offset:32
  s_branch fg_stored
fg_fin2:
  s_cmp_lg_u32 s3, 2
  s_cbranch_scc1 fg_fin3
  ds_read_b128 v[86:89], v157 offset:0
  ds_read_b128 v[90:93], v157 offset:1024
  ds_read_b128 v[94:97], v157 offset:2048
  ds_read_b128 v[98:101], v157 offset:3072
  ds_read_b128 v[102:105], v158 offset:0
  ds_read_b128 v[106:109], v158 offset:1024
  ds_read_b128 v[110:113], v158 offset:2048
  ds_read_b128 v[114:117], v158 offset:3072
  ds_read_b128 v[134:137], v159 offset:0
  ds_read_b128 v[138:141], v159 offset:1024
  ds_read_b128 v[142:145], v159 offset:2048
  ds_read_b128 v[146:149], v159 offset:3072
  s_waitcnt lgkmcnt(8)
  v_pk_add_f32 v[118:119], v[118:119], v[86:87]
  v_pk_add_f32 v[120:121], v[120:121], v[88:89]
  v_pk_add_f32 v[122:123], v[122:123], v[90:91]
  v_pk_add_f32 v[124:125], v[124:125], v[92:93]
  v_pk_add_f32 v[126:127], v[126:127], v[94:95]
  v_pk_add_f32 v[128:129], v[128:129], v[96:97]
  v_pk_add_f32 v[130:131], v[130:131], v[98:99]
  v_pk_add_f32 v[132:133], v[132:133], v[100:101]
  s_waitcnt lgkmcnt(4)
  v_pk_add_f32 v[118:119], v[118:119], v[102:103]
  v_pk_add_f32 v[120:121], v[120:121], v[104:105]
  v_pk_add_f32 v[122:123], v[122:123], v[106:107]
  v_pk_add_f32 v[124:125], v[124:125], v[108:109]
  v_pk_add_f32 v[126:127], v[126:127], v[110:111]
  v_pk_add_f32 v[128:129], v[128:129], v[112:113]
  v_pk_add_f32 v[130:131], v[130:131], v[114:115]
  v_pk_add_f32 v[132:133], v[132:133], v[116:117]
  s_waitcnt lgkmcnt(0)
  v_pk_add_f32 v[118:119], v[118:119], v[134:135]
  v_pk_add_f32 v[120:121], v[120:121], v[136:137]
  v_pk_add_f32 v[122:123], v[122:123], v[138:139]
  v_pk_add_f32 v[124:125], v[124:125], v[140:141]
  v_pk_add_f32 v[126:127], v[126:127], v[142:143]
  v_pk_add_f32 v[128:129], v[128:129], v[144:145]
  v_pk_add_f32 v[130:131], v[130:131], v[146:147]
  v_pk_add_f32 v[132:133], v[132:133], v[148:149]
  v_cvt_pk_bf16_f32 v22, v118, v119
  v_cvt_pk_bf16_f32 v23, v120, v121
  v_cvt_pk_bf16_f32 v24, v122, v123
  v_cvt_pk_bf16_f32 v25, v124, v125
  buffer_store_dwordx4 v[22:25], v160, s[24:27], s46 offen offset:0
  v_cvt_pk_bf16_f32 v26, v126, v127
  v_cvt_pk_bf16_f32 v27, v128, v129
  v_cvt_pk_bf16_f32 v28, v130, v131
  v_cvt_pk_bf16_f32 v29, v132, v133
  buffer_store_dwordx4 v[26:29], v160, s[24:27], s46 offen offset:32
  s_branch fg_stored
fg_fin3:
  ds_read_b128 v[86:89], v157 offset:0
  ds_read_b128 v[90:93], v157 offset:1024
  ds_read_b128 v[94:97], v157 offset:2048
  ds_read_b128 v[98:101], v157 offset:3072
  ds_read_b128 v[102:105], v158 offset:0
  ds_read_b128 v[106:109], v158 offset:1024
  ds_read_b128 v[110:113], v158 offset:2048
  ds_read_b128 v[114:117], v158 offset:3072
  ds_read_b128 v[118:121], v159 offset:0
  ds_read_b128 v[122:125], v159 offset:1024
  ds_read_b128 v[126:129], v159 offset:2048
  ds_read_b128 v[130:133], v159 offset:3072
  s_waitcnt lgkmcnt(8)
  v_pk_add_f32 v[134:135], v[134:135], v[86:87]
  v_pk_add_f32 v[136:137], v[136:137], v[88:89]
  v_pk_add_f32 v[138:139], v[138:139], v[90:91]
  v_pk_add_f32 v[140:141], v[140:141], v[92:93]
  v_pk_add_f32 v[142:143], v[142:143], v[94:95]
  v_pk_add_f32 v[144:145], v[144:145], v[96:97]
  v_pk_add_f32 v[146:147], v[146:147], v[98:99]
  v_pk_add_f32 v[148:149], v[148:149], v[100:101]
  s_waitcnt lgkmcnt(4)
  v_pk_add_f32 v[134:135], v[134:135], v[102:103]
  v_pk_add_f32 v[136:137], v[136:137], v[104:105]
  v_pk_add_f32 v[138:139], v[138:139], v[106:107]
  v_pk_add_f32 v[140:141], v[140:141], v[108:109]
  v_pk_add_f32 v[142:143], v[142:143], v[110:111]
  v_pk_add_f32 v[144:145], v[144:145], v[112:113]
  v_pk_add_f32 v[146:147], v[146:147], v[114:115]
  v_pk_add_f32 v[148:149], v[148:149], v[116:117]
  s_waitcnt lgkmcnt(0)
  v_pk_add_f32 v[134:135], v[134:135], v[118:119]
  v_pk_add_f32 v[136:137], v[136:137], v[120:121]
  v_pk_add_f32 v[138:139], v[138:139], v[122:123]
  v_pk_add_f32 v[140:141], v[140:141], v[124:125]
  v_pk_add_f32 v[142:143], v[142:143], v[126:127]
  v_pk_add_f32 v[144:145], v[144:145], v[128:129]
  v_pk_add_f32 v[146:147], v[146:147], v[130:131]
  v_pk_add_f32 v[148:149], v[148:149], v[132:133]
  v_cvt_pk_bf16_f32 v22, v134, v135
  v_cvt_pk_bf16_f32 v23, v136, v137
  v_cvt_pk_bf16_f32 v24, v138, v139
  v_cvt_pk_bf16_f32 v25, v140, v141
  buffer_store_dwordx4 v[22:25], v160, s[24:27], s46 offen offset:0
  v_cvt_pk_bf16_f32 v26, v142, v143
  v_cvt_pk_bf16_f32 v27, v144, v145
  v_cvt_pk_bf16_f32 v28, v146, v147
  v_cvt_pk_bf16_f32 v29, v148, v149
  buffer_store_dwordx4 v[26:29], v160, s[24:27], s46 offen offset:32
fg_stored:
  s_endpgm
km_exit:
  s_endpgm
.section .rodata,"a"
.p2align 6
.amdhsa_kernel gated_mix__mha_block__mixer_channel_mlp__prompt_kernel
  .amdhsa_next_free_vgpr 168
  .amdhsa_next_free_sgpr 102
  .amdhsa_accum_offset 168
  .amdhsa_group_segment_fixed_size 0
  .amdhsa_kernarg_size 96
  .amdhsa_user_sgpr_count 2
  .amdhsa_user_sgpr_kernarg_segment_ptr 1
  .amdhsa_system_sgpr_workgroup_id_x 1
  .amdhsa_float_denorm_mode_32 3
.end_amdhsa_kernel
```
